```python
import torch

def _softmax(x, axis=-1):
    return torch.softmax(x, dim=axis)
def _gelu(x):
    return torch.nn.functional.gelu(x, approximate="tanh")
def _silu(x):
    return torch.nn.functional.silu(x)
def _sigmoid(x):
    return torch.sigmoid(x)
def _layernorm(x, axis=-1, eps=1e-5):
    m = x.mean(dim=axis, keepdim=True)
    v = x.var(dim=axis, keepdim=True, unbiased=False)
    return (x - m) / torch.sqrt(v + eps)
def _scatter_add(tgt, idx, src, axis=0):
    return tgt.clone().index_add_(axis, idx, src)
def _segment_sum(src, seg, n):
    out = torch.zeros((n,) + src.shape[1:], dtype=src.dtype)
    return out.index_add_(0, seg, src)
def _pad(x, pw):
    flat = tuple(v for pair in reversed(pw) for v in pair)
    return torch.nn.functional.pad(x, flat)

kernel_name = 'standalone__gqa_block_cached__near_ridge'

def setup_inputs():

    _w = (lambda a: (lambda t: t.to(torch.bfloat16) if t.is_floating_point() else t)(torch.as_tensor(a)))
    B, Sq, D = 8, 64, 512
    Hq, Hkv, Sk, Dh = 32, 8, 64, 128
    assert Hq % Hkv == 0, (Hq, Hkv)
    return {
        "x": _w((lambda *s: torch.randn(*s, dtype=torch.bfloat16) * 0.8)(B, Sq, D)),
        "k_cache": _w((lambda *s: torch.randn(*s, dtype=torch.bfloat16) * 0.8)(B, Hkv, Sk, Dh)),
        "v_cache": _w((lambda *s: torch.randn(*s, dtype=torch.bfloat16) * 0.05)(B, Hkv, Sk, Dh)),
        "wq": _w((lambda *s: torch.randn(*s, dtype=torch.bfloat16) * 0.8)(D, Hq * Dh) * (D ** -0.5)),
        "wo": _w((lambda *s: torch.randn(*s, dtype=torch.bfloat16) * 0.05)(Hq * Dh, D) * ((Hq * Dh) ** -0.5)),
    }

def reference(x, k_cache, v_cache, wq, wo):
    B, Sq, D = x.shape
    Hq, Dh = 32, 128
    Hkv = k_cache.shape[1]
    rep = Hq // Hkv
    q = (lambda x, *d: x.permute(*d))((x @ wq).reshape(B, Sq, Hq, Dh), 0, 2, 1, 3)
    k = (lambda x, n, axis: torch.repeat_interleave(x, n, dim=axis))(k_cache, rep, axis=1)
    v = (lambda x, n, axis: torch.repeat_interleave(x, n, dim=axis))(v_cache, rep, axis=1)
    scores = torch.einsum("bhqd,bhkd->bhqk", q, k) * (Dh ** -0.5)
    p = _softmax(scores, axis=-1)
    o = torch.einsum("bhqk,bhkd->bhqd", p, v)
    return (lambda x, *d: x.permute(*d))(o, 0, 2, 1, 3).reshape(B, Sq, Hq * Dh) @ wo
```

```asm
; @launch grid=(256,1,1) block=(256,1,1) lds=163840
.amdgcn_target "amdgcn-amd-amdhsa--gfx950"
.text
.globl standalone__gqa_block_cached__near_ridge_kernel
.p2align 8
.type standalone__gqa_block_cached__near_ridge_kernel,@function
standalone__gqa_block_cached__near_ridge_kernel:
    s_cmp_ge_u32 s2, 256
    s_cbranch_scc1 L_done
    s_getpc_b64 s[98:99]
L_pc:
    v_and_b32 v224, 0xc0, v0
    v_lshlrev_b32 v224, 6, v224
    v_and_b32 v225, 63, v0
    v_lshl_add_u32 v224, v225, 6, v224
    v_min_u32 v224, L_done-L_pc, v224
    v_mov_b32 v227, s99
    v_add_co_u32 v226, vcc, s98, v224
    s_nop 1
    v_addc_co_u32 v227, vcc, 0, v227, vcc
    global_load_dword v241, v[226:227], off
    s_load_dwordx4 s[4:7], s[0:1], 0
    s_load_dwordx4 s[8:11], s[0:1], 16
    s_load_dwordx4 s[12:15], s[0:1], 32
    s_load_dwordx4 s[16:19], s[0:1], 48
    v_lshrrev_b32 v2, 6, v0
    v_and_b32 v1, 63, v0
    v_readfirstlane_b32 s20, v2
    s_and_b32 s23, s2, 7
    s_lshr_b32 s66, s2, 3
    s_and_b32 s66, s66, 3
    s_lshl_b32 s21, s23, 2
    s_add_u32 s21, s21, s66
    s_lshr_b32 s22, s2, 5
    s_add_u32 s24, s66, s22
    s_and_b32 s24, s24, 3
    s_lshl_b32 s24, s24, 1
    v_lshrrev_b32 v36, 3, v1
    v_and_b32 v37, 7, v1
    v_lshrrev_b32 v38, 1, v36
    v_xor_b32 v37, v37, v38
    v_lshlrev_b32 v37, 4, v37
    v_lshl_add_u32 v2, v36, 10, v37
    v_xor_b32 v3, 64, v2
    v_add_u32 v3, 8192, v3
    v_lshrrev_b32 v36, 4, v1
    v_and_b32 v37, 15, v1
    v_lshlrev_b32 v38, 2, v36
    v_xor_b32 v38, v37, v38
    v_lshlrev_b32 v38, 4, v38
    v_lshl_add_u32 v4, v36, 13, v38
    v_add_u32 v5, 0x8000, v4
    v_add_u32 v6, 0x10000, v4
    v_add_u32 v7, 0x18000, v4
    s_lshl_b32 s60, s20, 14
    s_lshl_b32 s61, s20, 17
    s_lshl_b32 s58, s20, 11
    s_lshl_b32 s59, s20, 12
    s_mov_b32 s70, s59
    s_add_u32 s59, s59, 40960
    s_waitcnt lgkmcnt(0)
    s_lshl_b32 s25, s22, 16
    s_add_u32 s28, s4, s25
    s_addc_u32 s29, s5, 0
    s_mov_b32 s30, 65536
    s_mov_b32 s31, 0x20000
    s_lshl_b32 s25, s21, 8
    s_add_u32 s32, s10, s25
    s_addc_u32 s33, s11, 0
    s_mov_b32 s34, 4186368
    s_mov_b32 s35, 0x20000
    s_add_u32 s84, s24, 0
    s_and_b32 s84, s84, 7
    s_lshl_b32 s56, s84, 7
    s_add_u32 s56, s56, s60
    s_lshl_b32 s57, s84, 19
    s_add_u32 s57, s57, s61
    s_add_u32 m0, s58, 0
    s_nop 0
    buffer_load_dwordx4 v2, s[28:31], s56 offen lds
    s_add_u32 m0, s58, 1024
    s_nop 0
    buffer_load_dwordx4 v3, s[28:31], s56 offen lds
    s_add_u32 m0, s59, 0
    s_nop 0
    buffer_load_dwordx4 v4, s[32:35], s57 offen lds
    s_add_u32 m0, s59, 1024
    s_nop 0
    buffer_load_dwordx4 v5, s[32:35], s57 offen lds
    s_add_u32 m0, s59, 2048
    s_nop 0
    buffer_load_dwordx4 v6, s[32:35], s57 offen lds
    s_add_u32 m0, s59, 3072
    s_nop 0
    buffer_load_dwordx4 v7, s[32:35], s57 offen lds
    s_add_u32 s84, s24, 1
    s_and_b32 s84, s84, 7
    s_lshl_b32 s56, s84, 7
    s_add_u32 s56, s56, s60
    s_lshl_b32 s57, s84, 19
    s_add_u32 s57, s57, s61
    s_add_u32 m0, s58, 8192
    s_nop 0
    buffer_load_dwordx4 v2, s[28:31], s56 offen lds
    s_add_u32 m0, s58, 9216
    s_nop 0
    buffer_load_dwordx4 v3, s[28:31], s56 offen lds
    s_add_u32 m0, s59, 16384
    s_nop 0
    buffer_load_dwordx4 v4, s[32:35], s57 offen lds
    s_add_u32 m0, s59, 17408
    s_nop 0
    buffer_load_dwordx4 v5, s[32:35], s57 offen lds
    s_add_u32 m0, s59, 18432
    s_nop 0
    buffer_load_dwordx4 v6, s[32:35], s57 offen lds
    s_add_u32 m0, s59, 19456
    s_nop 0
    buffer_load_dwordx4 v7, s[32:35], s57 offen lds
    s_lshr_b32 s68, s23, 1
    s_and_b32 s69, s23, 1
    s_lshl_b32 s69, s69, 2
    s_add_u32 s69, s69, s66
    s_lshl_b32 s25, s22, 3
    s_add_u32 s25, s25, s23
    s_lshl_b32 s25, s25, 14
    s_add_u32 s36, s6, s25
    s_addc_u32 s37, s7, 0
    s_mov_b32 s38, 16384
    s_mov_b32 s39, 0x20000
    s_add_u32 s40, s8, s25
    s_addc_u32 s41, s9, 0
    s_mov_b32 s42, 16384
    s_mov_b32 s43, 0x20000
    s_mov_b32 s44, s18
    s_mov_b32 s45, s19
    s_mov_b32 s46, 268435456
    s_mov_b32 s47, 0x20000
    s_lshl_b32 s25, s68, 20
    s_lshl_b32 s26, s69, 7
    s_add_u32 s25, s25, s26
    s_add_u32 s48, s12, s25
    s_addc_u32 s49, s13, 0
    s_mov_b32 s50, 1047680
    s_mov_b32 s51, 0x20000
    s_mov_b32 s52, s14
    s_mov_b32 s53, s15
    s_mov_b32 s54, 524288
    s_mov_b32 s55, 0x20000
    s_lshl_b32 s25, s22, 7
    s_add_u32 s25, s25, 65536
    s_load_dword s67, s[18:19], s25
    v_xor_b32 v38, v37, v36
    v_lshlrev_b32 v38, 4, v38
    v_lshl_add_u32 v8, v36, 8, v38
    v_xor_b32 v9, 64, v8
    v_xor_b32 v10, 128, v8
    v_xor_b32 v11, 192, v8
    v_lshlrev_b32 v38, 1, v36
    v_xor_b32 v38, v37, v38
    v_lshlrev_b32 v38, 4, v38
    v_lshl_add_u32 v12, v36, 8, v38
    v_xor_b32 v13, 128, v12
    v_lshrrev_b32 v36, 3, v1
    v_and_b32 v37, 7, v1
    v_bfe_u32 v38, v1, 4, 2
    v_lshlrev_b32 v38, 1, v38
    v_xor_b32 v37, v37, v38
    v_lshlrev_b32 v37, 4, v37
    v_lshl_add_u32 v14, v36, 10, v37
    s_lshl_b32 s85, s20, 10
    s_lshl_b32 s86, s20, 13
    v_and_b32 v36, 15, v1
    v_lshlrev_b32 v15, 7, v36
    s_lshl_b32 s95, s66, 12
    s_and_b32 s25, s20, 1
    s_lshl_b32 s25, s25, 11
    s_add_u32 s95, s95, s25
    v_and_b32 v36, 31, v1
    v_lshlrev_b32 v16, 10, v36
    s_lshl_b32 s96, s22, 17
    s_lshl_b32 s25, s20, 15
    s_add_u32 s96, s96, s25
    v_lshlrev_b32 v240, 4, v1
    s_lshl_b32 s25, s22, 1
    s_lshr_b32 s26, s20, 1
    s_add_u32 s25, s25, s26
    s_lshl_b32 s25, s25, 5
    s_add_u32 s25, s25, s21
    s_lshl_b32 s25, s25, 13
    s_and_b32 s26, s20, 1
    s_lshl_b32 s26, s26, 10
    s_add_u32 s25, s25, s26
    s_add_u32 s87, s25, 1048576
    s_lshl_b32 s25, s22, 3
    s_add_u32 s25, s25, s23
    s_lshl_b32 s25, s25, 1
    s_lshr_b32 s26, s20, 1
    s_add_u32 s25, s25, s26
    s_lshl_b32 s25, s25, 7
    s_lshl_b32 s26, s66, 1
    s_and_b32 s27, s20, 1
    s_add_u32 s26, s26, s27
    s_lshl_b32 s26, s26, 2
    s_add_u32 s25, s25, s26
    s_add_u32 s94, s25, 131072
    s_lshl_b32 s25, s22, 3
    s_lshl_b32 s26, s68, 1
    s_add_u32 s25, s25, s26
    s_lshr_b32 s26, s20, 1
    s_add_u32 s25, s25, s26
    s_lshl_b32 s25, s25, 1
    s_and_b32 s26, s20, 1
    s_add_u32 s25, s25, s26
    s_lshl_b32 s25, s25, 7
    s_add_u32 s25, s25, 131072
    v_and_b32 v35, 7, v1
    v_lshlrev_b32 v35, 2, v35
    v_add_u32 v35, s25, v35
    s_bitcmp1_b32 s20, 1
    s_cbranch_scc1 L_kt_2
    buffer_load_dword v241, v15, s[36:39], s95 offen
    s_branch L_kt_3
L_kt_2:
    buffer_load_dword v241, v15, s[40:43], s95 offen
L_kt_3:
    s_lshr_b32 s62, s20, 1
    s_and_b32 s63, s20, 1
    v_and_b32 v36, 31, v1
    v_lshrrev_b32 v37, 5, v1
    v_bfe_u32 v38, v1, 1, 3
    v_xor_b32 v38, v38, v37
    v_lshlrev_b32 v38, 4, v38
    v_lshl_add_u32 v38, v36, 7, v38
    s_lshl_b32 s64, s62, 12
    v_add_u32 v17, s64, v38
    v_xor_b32 v18, 32, v17
    v_xor_b32 v19, 64, v17
    v_xor_b32 v20, 96, v17
    v_bfe_u32 v36, v1, 2, 2
    v_bfe_u32 v38, v1, 4, 1
    v_bfe_u32 v39, v1, 1, 1
    v_lshl_add_u32 v38, v38, 1, v39
    s_lshl_b32 s64, s63, 3
    v_add_u32 v38, s64, v38
    v_lshlrev_b32 v39, 2, v36
    v_xor_b32 v38, v38, v39
    v_lshlrev_b32 v38, 4, v38
    v_lshl_add_u32 v36, v37, 3, v36
    v_lshl_add_u32 v38, v36, 8, v38
    v_and_b32 v39, 1, v1
    v_lshl_add_u32 v38, v39, 3, v38
    v_add_u32 v21, 40960, v38
    v_xor_b32 v22, 64, v21
    v_add_u32 v23, 0x10000, v21
    v_add_u32 v24, 0x10000, v22
    v_and_b32 v36, 15, v1
    v_lshrrev_b32 v37, 4, v1
    v_xor_b32 v38, v36, v37
    v_lshlrev_b32 v38, 4, v38
    v_lshl_add_u32 v38, v36, 8, v38
    v_add_u32 v25, 147456, v38
    v_xor_b32 v26, 64, v25
    v_xor_b32 v27, 128, v25
    v_xor_b32 v28, 192, v25
    s_lshl_b32 s64, s20, 12
    s_add_u32 s64, s64, 57344
    v_add_u32 v29, s64, v38
    v_xor_b32 v30, 64, v29
    v_xor_b32 v31, 128, v29
    v_xor_b32 v32, 192, v29
    v_and_b32 v38, 31, v1
    v_lshrrev_b32 v39, 5, v1
    s_lshl_b32 s64, s63, 3
    v_xor_b32 v36, s64, v36
    v_lshlrev_b32 v36, 4, v36
    v_lshl_add_u32 v36, v38, 8, v36
    v_lshl_add_u32 v36, v39, 3, v36
    s_lshl_b32 s64, s62, 13
    s_add_u32 s64, s64, 57344
    v_add_u32 v33, s64, v36
    v_bfe_u32 v36, v1, 2, 2
    v_lshl_add_u32 v38, v37, 2, v36
    v_and_b32 v39, 7, v38
    v_lshlrev_b32 v39, 1, v39
    v_bfe_u32 v36, v1, 1, 1
    v_xor_b32 v39, v39, v36
    v_lshlrev_b32 v39, 4, v39
    v_lshl_add_u32 v38, v38, 8, v39
    v_and_b32 v36, 1, v1
    v_lshl_add_u32 v38, v36, 3, v38
    v_add_u32 v34, 131072, v38
    v_mov_b32 v242, 0x3e0293ee
    v_mov_b32 v243, 0x3e0293ee
    v_mov_b32 v248, 0x3f803f80
    v_mov_b32 v249, 0x3f803f80
    v_mov_b32 v250, 0x3f803f80
    v_mov_b32 v251, 0x3f803f80
    s_add_u32 s84, s24, 2
    s_and_b32 s84, s84, 7
    s_lshl_b32 s56, s84, 7
    s_add_u32 s56, s56, s60
    s_lshl_b32 s57, s84, 19
    s_add_u32 s57, s57, s61
    s_add_u32 m0, s58, 16384
    s_nop 0
    buffer_load_dwordx4 v2, s[28:31], s56 offen lds
    s_add_u32 m0, s58, 17408
    s_nop 0
    buffer_load_dwordx4 v3, s[28:31], s56 offen lds
    s_add_u32 m0, s59, 32768
    s_nop 0
    buffer_load_dwordx4 v4, s[32:35], s57 offen lds
    s_add_u32 m0, s59, 33792
    s_nop 0
    buffer_load_dwordx4 v5, s[32:35], s57 offen lds
    s_add_u32 m0, s59, 34816
    s_nop 0
    buffer_load_dwordx4 v6, s[32:35], s57 offen lds
    s_add_u32 m0, s59, 35840
    s_nop 0
    buffer_load_dwordx4 v7, s[32:35], s57 offen lds
    s_waitcnt vmcnt(13) lgkmcnt(0)
    s_mul_i32 s67, s67, 0x9e3779b1
    s_add_u32 s67, s67, 0x7f4a7c15
    s_barrier
    ds_read_b128 v[40:43], v17 offset:0
    ds_read_b64_tr_b16 v[44:45], v21 offset:0
    ds_read_b64_tr_b16 v[46:47], v21 offset:1024
    ds_read_b64_tr_b16 v[48:49], v22 offset:0
    ds_read_b64_tr_b16 v[50:51], v22 offset:1024
    ds_read_b128 v[52:55], v18 offset:0
    ds_read_b64_tr_b16 v[56:57], v21 offset:4096
    ds_read_b64_tr_b16 v[58:59], v21 offset:5120
    ds_read_b64_tr_b16 v[60:61], v22 offset:4096
    ds_read_b64_tr_b16 v[62:63], v22 offset:5120
    ds_read_b128 v[64:67], v19 offset:0
    ds_read_b64_tr_b16 v[68:69], v21 offset:8192
    ds_read_b64_tr_b16 v[70:71], v21 offset:9216
    ds_read_b64_tr_b16 v[72:73], v22 offset:8192
    ds_read_b64_tr_b16 v[74:75], v22 offset:9216
    s_waitcnt lgkmcnt(10)
    v_mfma_f32_32x32x16_bf16 v[88:103], v[44:47], v[40:43], 0
    ds_read_b128 v[76:79], v20 offset:0
    ds_read_b64_tr_b16 v[80:81], v21 offset:12288
    ds_read_b64_tr_b16 v[82:83], v21 offset:13312
    s_add_u32 s84, s24, 3
    s_and_b32 s84, s84, 7
    s_lshl_b32 s56, s84, 7
    s_add_u32 s56, s56, s60
    s_lshl_b32 s57, s84, 19
    s_add_u32 s57, s57, s61
    s_add_u32 m0, s58, 24576
    s_nop 0
    buffer_load_dwordx4 v2, s[28:31], s56 offen lds
    v_mfma_f32_32x32x16_bf16 v[104:119], v[48:51], v[40:43], 0
    ds_read_b64_tr_b16 v[84:85], v22 offset:12288
    ds_read_b64_tr_b16 v[86:87], v22 offset:13312
    s_add_u32 m0, s58, 25600
    s_nop 0
    buffer_load_dwordx4 v3, s[28:31], s56 offen lds
    s_waitcnt lgkmcnt(10)
    v_mfma_f32_32x32x16_bf16 v[88:103], v[56:59], v[52:55], v[88:103]
    s_waitcnt vmcnt(9)
    s_barrier
    ds_read_b128 v[40:43], v17 offset:8192
    ds_read_b64_tr_b16 v[44:45], v21 offset:16384
    ds_read_b64_tr_b16 v[46:47], v21 offset:17408
    s_add_u32 m0, s59, 49152
    s_nop 0
    buffer_load_dwordx4 v4, s[32:35], s57 offen lds
    v_mfma_f32_32x32x16_bf16 v[104:119], v[60:63], v[52:55], v[104:119]
    ds_read_b64_tr_b16 v[48:49], v22 offset:16384
    ds_read_b64_tr_b16 v[50:51], v22 offset:17408
    s_add_u32 m0, s59, 50176
    s_nop 0
    buffer_load_dwordx4 v5, s[32:35], s57 offen lds
    s_waitcnt lgkmcnt(10)
    v_mfma_f32_32x32x16_bf16 v[88:103], v[68:71], v[64:67], v[88:103]
    ds_read_b128 v[52:55], v18 offset:8192
    ds_read_b64_tr_b16 v[56:57], v21 offset:20480
    ds_read_b64_tr_b16 v[58:59], v21 offset:21504
    s_add_u32 m0, s59, 51200
    s_nop 0
    buffer_load_dwordx4 v6, s[32:35], s57 offen lds
    v_mfma_f32_32x32x16_bf16 v[104:119], v[72:75], v[64:67], v[104:119]
    ds_read_b64_tr_b16 v[60:61], v22 offset:20480
    ds_read_b64_tr_b16 v[62:63], v22 offset:21504
    s_add_u32 m0, s59, 52224
    s_nop 0
    buffer_load_dwordx4 v7, s[32:35], s57 offen lds
    s_waitcnt lgkmcnt(10)
    v_mfma_f32_32x32x16_bf16 v[88:103], v[80:83], v[76:79], v[88:103]
    ds_read_b128 v[64:67], v19 offset:8192
    ds_read_b64_tr_b16 v[68:69], v21 offset:24576
    ds_read_b64_tr_b16 v[70:71], v21 offset:25600
    s_add_u32 s84, s24, 4
    s_and_b32 s84, s84, 7
    s_lshl_b32 s56, s84, 7
    s_add_u32 s56, s56, s60
    s_lshl_b32 s57, s84, 19
    s_add_u32 s57, s57, s61
    s_add_u32 m0, s58, 32768
    s_nop 0
    buffer_load_dwordx4 v2, s[28:31], s56 offen lds
    v_mfma_f32_32x32x16_bf16 v[104:119], v[84:87], v[76:79], v[104:119]
    ds_read_b64_tr_b16 v[72:73], v22 offset:24576
    ds_read_b64_tr_b16 v[74:75], v22 offset:25600
    s_add_u32 m0, s58, 33792
    s_nop 0
    buffer_load_dwordx4 v3, s[28:31], s56 offen lds
    s_waitcnt lgkmcnt(10)
    v_mfma_f32_32x32x16_bf16 v[88:103], v[44:47], v[40:43], v[88:103]
    ds_read_b128 v[76:79], v20 offset:8192
    ds_read_b64_tr_b16 v[80:81], v21 offset:28672
    ds_read_b64_tr_b16 v[82:83], v21 offset:29696
    s_add_u32 m0, s59, 65536
    s_nop 0
    buffer_load_dwordx4 v4, s[32:35], s57 offen lds
    v_mfma_f32_32x32x16_bf16 v[104:119], v[48:51], v[40:43], v[104:119]
    ds_read_b64_tr_b16 v[84:85], v22 offset:28672
    ds_read_b64_tr_b16 v[86:87], v22 offset:29696
    s_add_u32 m0, s59, 66560
    s_nop 0
    buffer_load_dwordx4 v5, s[32:35], s57 offen lds
    s_waitcnt lgkmcnt(10)
    v_mfma_f32_32x32x16_bf16 v[88:103], v[56:59], v[52:55], v[88:103]
    s_waitcnt vmcnt(10)
    s_barrier
    ds_read_b128 v[40:43], v17 offset:16384
    ds_read_b64_tr_b16 v[44:45], v21 offset:32768
    ds_read_b64_tr_b16 v[46:47], v21 offset:33792
    s_add_u32 m0, s59, 67584
    s_nop 0
    buffer_load_dwordx4 v6, s[32:35], s57 offen lds
    v_mfma_f32_32x32x16_bf16 v[104:119], v[60:63], v[52:55], v[104:119]
    ds_read_b64_tr_b16 v[48:49], v22 offset:32768
    ds_read_b64_tr_b16 v[50:51], v22 offset:33792
    s_add_u32 m0, s59, 68608
    s_nop 0
    buffer_load_dwordx4 v7, s[32:35], s57 offen lds
    s_waitcnt lgkmcnt(10)
    v_mfma_f32_32x32x16_bf16 v[88:103], v[68:71], v[64:67], v[88:103]
    ds_read_b128 v[52:55], v18 offset:16384
    ds_read_b64_tr_b16 v[56:57], v21 offset:36864
    ds_read_b64_tr_b16 v[58:59], v21 offset:37888
    s_add_u32 s84, s24, 5
    s_and_b32 s84, s84, 7
    s_lshl_b32 s56, s84, 7
    s_add_u32 s56, s56, s60
    s_lshl_b32 s57, s84, 19
    s_add_u32 s57, s57, s61
    s_add_u32 m0, s58, 0
    s_nop 0
    buffer_load_dwordx4 v2, s[28:31], s56 offen lds
    v_mfma_f32_32x32x16_bf16 v[104:119], v[72:75], v[64:67], v[104:119]
    ds_read_b64_tr_b16 v[60:61], v22 offset:36864
    ds_read_b64_tr_b16 v[62:63], v22 offset:37888
    s_add_u32 m0, s58, 1024
    s_nop 0
    buffer_load_dwordx4 v3, s[28:31], s56 offen lds
    s_waitcnt lgkmcnt(10)
    v_mfma_f32_32x32x16_bf16 v[88:103], v[80:83], v[76:79], v[88:103]
    ds_read_b128 v[64:67], v19 offset:16384
    ds_read_b64_tr_b16 v[68:69], v21 offset:40960
    ds_read_b64_tr_b16 v[70:71], v21 offset:41984
    s_add_u32 m0, s59, 0
    s_nop 0
    buffer_load_dwordx4 v4, s[32:35], s57 offen lds
    v_mfma_f32_32x32x16_bf16 v[104:119], v[84:87], v[76:79], v[104:119]
    ds_read_b64_tr_b16 v[72:73], v22 offset:40960
    ds_read_b64_tr_b16 v[74:75], v22 offset:41984
    s_add_u32 m0, s59, 1024
    s_nop 0
    buffer_load_dwordx4 v5, s[32:35], s57 offen lds
    s_waitcnt lgkmcnt(10)
    v_mfma_f32_32x32x16_bf16 v[88:103], v[44:47], v[40:43], v[88:103]
    ds_read_b128 v[76:79], v20 offset:16384
    ds_read_b64_tr_b16 v[80:81], v21 offset:45056
    ds_read_b64_tr_b16 v[82:83], v21 offset:46080
    s_add_u32 m0, s59, 2048
    s_nop 0
    buffer_load_dwordx4 v6, s[32:35], s57 offen lds
    v_mfma_f32_32x32x16_bf16 v[104:119], v[48:51], v[40:43], v[104:119]
    ds_read_b64_tr_b16 v[84:85], v22 offset:45056
    ds_read_b64_tr_b16 v[86:87], v22 offset:46080
    s_add_u32 m0, s59, 3072
    s_nop 0
    buffer_load_dwordx4 v7, s[32:35], s57 offen lds
    s_waitcnt lgkmcnt(10)
    v_mfma_f32_32x32x16_bf16 v[88:103], v[56:59], v[52:55], v[88:103]
    s_waitcnt vmcnt(12)
    s_barrier
    ds_read_b128 v[40:43], v17 offset:24576
    ds_read_b64_tr_b16 v[44:45], v21 offset:49152
    ds_read_b64_tr_b16 v[46:47], v21 offset:50176
    s_add_u32 s84, s24, 6
    s_and_b32 s84, s84, 7
    s_lshl_b32 s56, s84, 7
    s_add_u32 s56, s56, s60
    s_lshl_b32 s57, s84, 19
    s_add_u32 s57, s57, s61
    s_add_u32 m0, s58, 8192
    s_nop 0
    buffer_load_dwordx4 v2, s[28:31], s56 offen lds
    v_mfma_f32_32x32x16_bf16 v[104:119], v[60:63], v[52:55], v[104:119]
    ds_read_b64_tr_b16 v[48:49], v22 offset:49152
    ds_read_b64_tr_b16 v[50:51], v22 offset:50176
    s_add_u32 m0, s58, 9216
    s_nop 0
    buffer_load_dwordx4 v3, s[28:31], s56 offen lds
    s_waitcnt lgkmcnt(10)
    v_mfma_f32_32x32x16_bf16 v[88:103], v[68:71], v[64:67], v[88:103]
    ds_read_b128 v[52:55], v18 offset:24576
    ds_read_b64_tr_b16 v[56:57], v21 offset:53248
    ds_read_b64_tr_b16 v[58:59], v21 offset:54272
    s_add_u32 m0, s59, 16384
    s_nop 0
    buffer_load_dwordx4 v4, s[32:35], s57 offen lds
    v_mfma_f32_32x32x16_bf16 v[104:119], v[72:75], v[64:67], v[104:119]
    ds_read_b64_tr_b16 v[60:61], v22 offset:53248
    ds_read_b64_tr_b16 v[62:63], v22 offset:54272
    s_add_u32 m0, s59, 17408
    s_nop 0
    buffer_load_dwordx4 v5, s[32:35], s57 offen lds
    s_waitcnt lgkmcnt(10)
    v_mfma_f32_32x32x16_bf16 v[88:103], v[80:83], v[76:79], v[88:103]
    ds_read_b128 v[64:67], v19 offset:24576
    ds_read_b64_tr_b16 v[68:69], v21 offset:57344
    ds_read_b64_tr_b16 v[70:71], v21 offset:58368
    s_add_u32 m0, s59, 18432
    s_nop 0
    buffer_load_dwordx4 v6, s[32:35], s57 offen lds
    v_mfma_f32_32x32x16_bf16 v[104:119], v[84:87], v[76:79], v[104:119]
    ds_read_b64_tr_b16 v[72:73], v22 offset:57344
    ds_read_b64_tr_b16 v[74:75], v22 offset:58368
    s_add_u32 m0, s59, 19456
    s_nop 0
    buffer_load_dwordx4 v7, s[32:35], s57 offen lds
    s_waitcnt lgkmcnt(10)
    v_mfma_f32_32x32x16_bf16 v[88:103], v[44:47], v[40:43], v[88:103]
    ds_read_b128 v[76:79], v20 offset:24576
    ds_read_b64_tr_b16 v[80:81], v21 offset:61440
    ds_read_b64_tr_b16 v[82:83], v21 offset:62464
    v_mfma_f32_32x32x16_bf16 v[104:119], v[48:51], v[40:43], v[104:119]
    ds_read_b64_tr_b16 v[84:85], v22 offset:61440
    ds_read_b64_tr_b16 v[86:87], v22 offset:62464
    s_waitcnt lgkmcnt(10)
    v_mfma_f32_32x32x16_bf16 v[88:103], v[56:59], v[52:55], v[88:103]
    s_waitcnt vmcnt(12)
    s_barrier
    ds_read_b128 v[40:43], v17 offset:32768
    ds_read_b64_tr_b16 v[44:45], v23 offset:0
    ds_read_b64_tr_b16 v[46:47], v23 offset:1024
    s_add_u32 s84, s24, 7
    s_and_b32 s84, s84, 7
    s_lshl_b32 s56, s84, 7
    s_add_u32 s56, s56, s60
    s_lshl_b32 s57, s84, 19
    s_add_u32 s57, s57, s61
    s_add_u32 m0, s58, 16384
    s_nop 0
    buffer_load_dwordx4 v2, s[28:31], s56 offen lds
    v_mfma_f32_32x32x16_bf16 v[104:119], v[60:63], v[52:55], v[104:119]
    ds_read_b64_tr_b16 v[48:49], v24 offset:0
    ds_read_b64_tr_b16 v[50:51], v24 offset:1024
    s_add_u32 m0, s58, 17408
    s_nop 0
    buffer_load_dwordx4 v3, s[28:31], s56 offen lds
    s_waitcnt lgkmcnt(10)
    v_mfma_f32_32x32x16_bf16 v[88:103], v[68:71], v[64:67], v[88:103]
    ds_read_b128 v[52:55], v18 offset:32768
    ds_read_b64_tr_b16 v[56:57], v23 offset:4096
    ds_read_b64_tr_b16 v[58:59], v23 offset:5120
    s_add_u32 m0, s59, 32768
    s_nop 0
    buffer_load_dwordx4 v4, s[32:35], s57 offen lds
    v_mfma_f32_32x32x16_bf16 v[104:119], v[72:75], v[64:67], v[104:119]
    ds_read_b64_tr_b16 v[60:61], v24 offset:4096
    ds_read_b64_tr_b16 v[62:63], v24 offset:5120
    s_add_u32 m0, s59, 33792
    s_nop 0
    buffer_load_dwordx4 v5, s[32:35], s57 offen lds
    s_waitcnt lgkmcnt(10)
    v_mfma_f32_32x32x16_bf16 v[88:103], v[80:83], v[76:79], v[88:103]
    ds_read_b128 v[64:67], v19 offset:32768
    ds_read_b64_tr_b16 v[68:69], v23 offset:8192
    ds_read_b64_tr_b16 v[70:71], v23 offset:9216
    s_add_u32 m0, s59, 34816
    s_nop 0
    buffer_load_dwordx4 v6, s[32:35], s57 offen lds
    v_mfma_f32_32x32x16_bf16 v[104:119], v[84:87], v[76:79], v[104:119]
    ds_read_b64_tr_b16 v[72:73], v24 offset:8192
    ds_read_b64_tr_b16 v[74:75], v24 offset:9216
    s_add_u32 m0, s59, 35840
    s_nop 0
    buffer_load_dwordx4 v7, s[32:35], s57 offen lds
    s_waitcnt lgkmcnt(10)
    v_mfma_f32_32x32x16_bf16 v[88:103], v[44:47], v[40:43], v[88:103]
    ds_read_b128 v[76:79], v20 offset:32768
    ds_read_b64_tr_b16 v[80:81], v23 offset:12288
    ds_read_b64_tr_b16 v[82:83], v23 offset:13312
    s_add_u32 m0, s70, 147456
    s_nop 0
    buffer_load_dwordx4 v8, s[36:39], s70 offen offset:0 lds
    v_mfma_f32_32x32x16_bf16 v[104:119], v[48:51], v[40:43], v[104:119]
    ds_read_b64_tr_b16 v[84:85], v24 offset:12288
    ds_read_b64_tr_b16 v[86:87], v24 offset:13312
    s_add_u32 m0, s70, 147456
    s_nop 0
    buffer_load_dwordx4 v9, s[36:39], s70 offen offset:1024 lds
    s_waitcnt lgkmcnt(10)
    v_mfma_f32_32x32x16_bf16 v[88:103], v[56:59], v[52:55], v[88:103]
    s_waitcnt vmcnt(14)
    s_barrier
    ds_read_b128 v[40:43], v17 offset:0
    ds_read_b64_tr_b16 v[44:45], v21 offset:0
    ds_read_b64_tr_b16 v[46:47], v21 offset:1024
    s_add_u32 m0, s70, 147456
    s_nop 0
    buffer_load_dwordx4 v10, s[36:39], s70 offen offset:2048 lds
    v_mfma_f32_32x32x16_bf16 v[104:119], v[60:63], v[52:55], v[104:119]
    ds_read_b64_tr_b16 v[48:49], v22 offset:0
    ds_read_b64_tr_b16 v[50:51], v22 offset:1024
    s_add_u32 m0, s70, 147456
    s_nop 0
    buffer_load_dwordx4 v11, s[36:39], s70 offen offset:3072 lds
    s_waitcnt lgkmcnt(10)
    v_mfma_f32_32x32x16_bf16 v[88:103], v[68:71], v[64:67], v[88:103]
    ds_read_b128 v[52:55], v18 offset:0
    ds_read_b64_tr_b16 v[56:57], v21 offset:4096
    ds_read_b64_tr_b16 v[58:59], v21 offset:5120
    s_add_u32 m0, s70, 131072
    s_nop 0
    buffer_load_dwordx4 v12, s[40:43], s70 offen offset:0 lds
    v_mfma_f32_32x32x16_bf16 v[104:119], v[72:75], v[64:67], v[104:119]
    ds_read_b64_tr_b16 v[60:61], v22 offset:4096
    ds_read_b64_tr_b16 v[62:63], v22 offset:5120
    s_add_u32 m0, s70, 131072
    s_nop 0
    buffer_load_dwordx4 v13, s[40:43], s70 offen offset:1024 lds
    s_waitcnt lgkmcnt(10)
    v_mfma_f32_32x32x16_bf16 v[88:103], v[80:83], v[76:79], v[88:103]
    ds_read_b128 v[64:67], v19 offset:0
    ds_read_b64_tr_b16 v[68:69], v21 offset:8192
    ds_read_b64_tr_b16 v[70:71], v21 offset:9216
    s_add_u32 m0, s70, 131072
    s_nop 0
    buffer_load_dwordx4 v12, s[40:43], s70 offen offset:2048 lds
    v_mfma_f32_32x32x16_bf16 v[104:119], v[84:87], v[76:79], v[104:119]
    ds_read_b64_tr_b16 v[72:73], v22 offset:8192
    ds_read_b64_tr_b16 v[74:75], v22 offset:9216
    s_add_u32 m0, s70, 131072
    s_nop 0
    buffer_load_dwordx4 v13, s[40:43], s70 offen offset:3072 lds
    s_waitcnt lgkmcnt(10)
    v_mfma_f32_32x32x16_bf16 v[88:103], v[44:47], v[40:43], v[88:103]
    ds_read_b128 v[76:79], v20 offset:0
    ds_read_b64_tr_b16 v[80:81], v21 offset:12288
    ds_read_b64_tr_b16 v[82:83], v21 offset:13312
    s_add_u32 s84, s96, 0
    buffer_load_dword v241, v16, s[48:51], s84 offen
    v_xor_b32 v232, 0, v33
    v_mfma_f32_32x32x16_bf16 v[104:119], v[48:51], v[40:43], v[104:119]
    ds_read_b64_tr_b16 v[84:85], v22 offset:12288
    ds_read_b64_tr_b16 v[86:87], v22 offset:13312
    v_xor_b32 v216, 0, v34
    s_waitcnt lgkmcnt(10)
    v_mfma_f32_32x32x16_bf16 v[88:103], v[56:59], v[52:55], v[88:103]
    s_waitcnt vmcnt(15)
    s_barrier
    ds_read_b128 v[40:43], v17 offset:8192
    ds_read_b64_tr_b16 v[44:45], v21 offset:16384
    ds_read_b64_tr_b16 v[46:47], v21 offset:17408
    v_xor_b32 v233, 16, v33
    v_mfma_f32_32x32x16_bf16 v[104:119], v[60:63], v[52:55], v[104:119]
    ds_read_b64_tr_b16 v[48:49], v22 offset:16384
    ds_read_b64_tr_b16 v[50:51], v22 offset:17408
    v_xor_b32 v217, 32, v34
    s_waitcnt lgkmcnt(10)
    v_mfma_f32_32x32x16_bf16 v[88:103], v[68:71], v[64:67], v[88:103]
    ds_read_b128 v[52:55], v18 offset:8192
    ds_read_b64_tr_b16 v[56:57], v21 offset:20480
    ds_read_b64_tr_b16 v[58:59], v21 offset:21504
    v_xor_b32 v234, 32, v33
    v_mfma_f32_32x32x16_bf16 v[104:119], v[72:75], v[64:67], v[104:119]
    ds_read_b64_tr_b16 v[60:61], v22 offset:20480
    ds_read_b64_tr_b16 v[62:63], v22 offset:21504
    v_xor_b32 v218, 64, v34
    s_waitcnt lgkmcnt(10)
    v_mfma_f32_32x32x16_bf16 v[88:103], v[80:83], v[76:79], v[88:103]
    ds_read_b128 v[64:67], v19 offset:8192
    ds_read_b64_tr_b16 v[68:69], v21 offset:24576
    ds_read_b64_tr_b16 v[70:71], v21 offset:25600
    v_xor_b32 v235, 48, v33
    v_mfma_f32_32x32x16_bf16 v[104:119], v[84:87], v[76:79], v[104:119]
    ds_read_b64_tr_b16 v[72:73], v22 offset:24576
    ds_read_b64_tr_b16 v[74:75], v22 offset:25600
    v_xor_b32 v219, 96, v34
    s_waitcnt lgkmcnt(10)
    v_mfma_f32_32x32x16_bf16 v[88:103], v[44:47], v[40:43], v[88:103]
    ds_read_b128 v[76:79], v20 offset:8192
    ds_read_b64_tr_b16 v[80:81], v21 offset:28672
    ds_read_b64_tr_b16 v[82:83], v21 offset:29696
    v_xor_b32 v236, 64, v33
    v_mfma_f32_32x32x16_bf16 v[104:119], v[48:51], v[40:43], v[104:119]
    ds_read_b64_tr_b16 v[84:85], v22 offset:28672
    ds_read_b64_tr_b16 v[86:87], v22 offset:29696
    v_xor_b32 v220, 128, v34
    s_waitcnt lgkmcnt(10)
    v_mfma_f32_32x32x16_bf16 v[88:103], v[56:59], v[52:55], v[88:103]
    s_waitcnt vmcnt(5)
    s_barrier
    ds_read_b128 v[40:43], v17 offset:16384
    ds_read_b64_tr_b16 v[44:45], v21 offset:32768
    ds_read_b64_tr_b16 v[46:47], v21 offset:33792
    v_xor_b32 v237, 80, v33
    v_mfma_f32_32x32x16_bf16 v[104:119], v[60:63], v[52:55], v[104:119]
    ds_read_b64_tr_b16 v[48:49], v22 offset:32768
    ds_read_b64_tr_b16 v[50:51], v22 offset:33792
    v_xor_b32 v221, 160, v34
    s_waitcnt lgkmcnt(10)
    v_mfma_f32_32x32x16_bf16 v[88:103], v[68:71], v[64:67], v[88:103]
    ds_read_b128 v[52:55], v18 offset:16384
    ds_read_b64_tr_b16 v[56:57], v21 offset:36864
    ds_read_b64_tr_b16 v[58:59], v21 offset:37888
    v_xor_b32 v238, 96, v33
    v_mfma_f32_32x32x16_bf16 v[104:119], v[72:75], v[64:67], v[104:119]
    ds_read_b64_tr_b16 v[60:61], v22 offset:36864
    ds_read_b64_tr_b16 v[62:63], v22 offset:37888
    ds_read_b128 v[120:123], v25 offset:0
    v_xor_b32 v222, 192, v34
    s_waitcnt lgkmcnt(11)
    v_mfma_f32_32x32x16_bf16 v[88:103], v[80:83], v[76:79], v[88:103]
    ds_read_b128 v[64:67], v19 offset:16384
    ds_read_b64_tr_b16 v[68:69], v21 offset:40960
    ds_read_b64_tr_b16 v[70:71], v21 offset:41984
    v_xor_b32 v239, 112, v33
    v_mfma_f32_32x32x16_bf16 v[104:119], v[84:87], v[76:79], v[104:119]
    ds_read_b64_tr_b16 v[72:73], v22 offset:40960
    ds_read_b64_tr_b16 v[74:75], v22 offset:41984
    ds_read_b128 v[136:139], v25 offset:4096
    v_xor_b32 v223, 224, v34
    s_waitcnt lgkmcnt(12)
    v_mfma_f32_32x32x16_bf16 v[88:103], v[44:47], v[40:43], v[88:103]
    ds_read_b128 v[76:79], v20 offset:16384
    ds_read_b64_tr_b16 v[80:81], v21 offset:45056
    ds_read_b64_tr_b16 v[82:83], v21 offset:46080
    v_mfma_f32_32x32x16_bf16 v[104:119], v[48:51], v[40:43], v[104:119]
    ds_read_b64_tr_b16 v[84:85], v22 offset:45056
    ds_read_b64_tr_b16 v[86:87], v22 offset:46080
    ds_read_b128 v[152:155], v25 offset:8192
    s_waitcnt lgkmcnt(13)
    v_mfma_f32_32x32x16_bf16 v[88:103], v[56:59], v[52:55], v[88:103]
    ds_read_b128 v[168:171], v25 offset:12288
    ds_read_b128 v[124:127], v26 offset:0
    ds_read_b128 v[140:143], v26 offset:4096
    v_mfma_f32_32x32x16_bf16 v[104:119], v[60:63], v[52:55], v[104:119]
    ds_read_b128 v[156:159], v26 offset:8192
    ds_read_b128 v[172:175], v26 offset:12288
    ds_read_b128 v[128:131], v27 offset:0
    s_waitcnt lgkmcnt(13)
    v_mfma_f32_32x32x16_bf16 v[88:103], v[68:71], v[64:67], v[88:103]
    ds_read_b128 v[144:147], v27 offset:4096
    ds_read_b128 v[160:163], v27 offset:8192
    ds_read_b128 v[176:179], v27 offset:12288
    s_waitcnt lgkmcnt(10)
    v_mfma_f32_32x32x16_bf16 v[88:103], v[80:83], v[76:79], v[88:103]
    ds_read_b128 v[132:135], v28 offset:0
    ds_read_b128 v[148:151], v28 offset:4096
    ds_read_b128 v[164:167], v28 offset:8192
    v_mfma_f32_32x32x16_bf16 v[104:119], v[72:75], v[64:67], v[104:119]
    s_waitcnt lgkmcnt(12)
    ds_read_b128 v[180:183], v28 offset:12288
    v_mfma_f32_32x32x16_bf16 v[104:119], v[84:87], v[76:79], v[104:119]
    s_nop 4
    v_cvt_pk_bf16_f32 v224, v88, v89
    v_cvt_pk_bf16_f32 v225, v90, v91
    ds_write_b64 v232, v[224:225]
    v_cvt_pk_bf16_f32 v226, v92, v93
    v_cvt_pk_bf16_f32 v227, v94, v95
    ds_write_b64 v233, v[226:227]
    v_cvt_pk_bf16_f32 v228, v96, v97
    v_cvt_pk_bf16_f32 v229, v98, v99
    ds_write_b64 v234, v[228:229]
    v_cvt_pk_bf16_f32 v230, v100, v101
    v_cvt_pk_bf16_f32 v231, v102, v103
    ds_write_b64 v235, v[230:231]
    v_cvt_pk_bf16_f32 v224, v104, v105
    v_cvt_pk_bf16_f32 v225, v106, v107
    ds_write_b64 v236, v[224:225]
    v_cvt_pk_bf16_f32 v226, v108, v109
    v_cvt_pk_bf16_f32 v227, v110, v111
    ds_write_b64 v237, v[226:227]
    v_cvt_pk_bf16_f32 v228, v112, v113
    v_cvt_pk_bf16_f32 v229, v114, v115
    ds_write_b64 v238, v[228:229]
    v_cvt_pk_bf16_f32 v230, v116, v117
    v_cvt_pk_bf16_f32 v231, v118, v119
    ds_write_b64 v239, v[230:231]
    s_waitcnt vmcnt(1) lgkmcnt(0)
    s_barrier
    ds_read_b128 v[184:187], v29
    ds_read_b128 v[188:191], v30
    ds_read_b128 v[192:195], v31
    ds_read_b128 v[196:199], v32
    ds_read_b64_tr_b16 v[40:41], v216 offset:0
    ds_read_b64_tr_b16 v[42:43], v216 offset:4096
    ds_read_b64_tr_b16 v[48:49], v217 offset:0
    ds_read_b64_tr_b16 v[50:51], v217 offset:4096
    ds_read_b64_tr_b16 v[56:57], v218 offset:0
    ds_read_b64_tr_b16 v[58:59], v218 offset:4096
    ds_read_b64_tr_b16 v[64:65], v219 offset:0
    ds_read_b64_tr_b16 v[66:67], v219 offset:4096
    s_waitcnt lgkmcnt(8)
    v_mfma_f32_16x16x32_bf16 v[200:203], v[120:123], v[184:187], 0
    ds_read_b64_tr_b16 v[72:73], v220 offset:0
    ds_read_b64_tr_b16 v[74:75], v220 offset:4096
    v_mfma_f32_16x16x32_bf16 v[200:203], v[124:127], v[188:191], v[200:203]
    ds_read_b64_tr_b16 v[80:81], v221 offset:0
    v_mfma_f32_16x16x32_bf16 v[200:203], v[128:131], v[192:195], v[200:203]
    ds_read_b64_tr_b16 v[82:83], v221 offset:4096
    ds_read_b64_tr_b16 v[88:89], v222 offset:0
    v_mfma_f32_16x16x32_bf16 v[200:203], v[132:135], v[196:199], v[200:203]
    ds_read_b64_tr_b16 v[90:91], v222 offset:4096
    v_mfma_f32_16x16x32_bf16 v[204:207], v[136:139], v[184:187], 0
    s_waitcnt lgkmcnt(7)
    ds_read_b64_tr_b16 v[96:97], v223 offset:0
    ds_read_b64_tr_b16 v[98:99], v223 offset:4096
    v_mfma_f32_16x16x32_bf16 v[204:207], v[140:143], v[188:191], v[204:207]
    ds_read_b64_tr_b16 v[44:45], v216 offset:8192
    v_mfma_f32_16x16x32_bf16 v[204:207], v[144:147], v[192:195], v[204:207]
    ds_read_b64_tr_b16 v[46:47], v216 offset:12288
    ds_read_b64_tr_b16 v[52:53], v217 offset:8192
    v_max3_f32 v36, v200, v201, v202
    v_max_f32 v36, v36, v203
    v_mfma_f32_16x16x32_bf16 v[204:207], v[148:151], v[196:199], v[204:207]
    ds_read_b64_tr_b16 v[54:55], v217 offset:12288
    v_mfma_f32_16x16x32_bf16 v[208:211], v[152:155], v[184:187], 0
    s_waitcnt lgkmcnt(7)
    ds_read_b64_tr_b16 v[60:61], v218 offset:8192
    ds_read_b64_tr_b16 v[62:63], v218 offset:12288
    v_mfma_f32_16x16x32_bf16 v[208:211], v[156:159], v[188:191], v[208:211]
    ds_read_b64_tr_b16 v[68:69], v219 offset:8192
    v_mfma_f32_16x16x32_bf16 v[208:211], v[160:163], v[192:195], v[208:211]
    ds_read_b64_tr_b16 v[70:71], v219 offset:12288
    ds_read_b64_tr_b16 v[76:77], v220 offset:8192
    v_max3_f32 v36, v36, v204, v205
    v_max3_f32 v36, v36, v206, v207
    v_mfma_f32_16x16x32_bf16 v[208:211], v[164:167], v[196:199], v[208:211]
    ds_read_b64_tr_b16 v[78:79], v220 offset:12288
    v_mfma_f32_16x16x32_bf16 v[212:215], v[168:171], v[184:187], 0
    s_waitcnt lgkmcnt(7)
    ds_read_b64_tr_b16 v[84:85], v221 offset:8192
    ds_read_b64_tr_b16 v[86:87], v221 offset:12288
    v_mfma_f32_16x16x32_bf16 v[212:215], v[172:175], v[188:191], v[212:215]
    ds_read_b64_tr_b16 v[92:93], v222 offset:8192
    v_mfma_f32_16x16x32_bf16 v[212:215], v[176:179], v[192:195], v[212:215]
    ds_read_b64_tr_b16 v[94:95], v222 offset:12288
    ds_read_b64_tr_b16 v[100:101], v223 offset:8192
    v_max3_f32 v36, v36, v208, v209
    v_max3_f32 v36, v36, v210, v211
    v_mfma_f32_16x16x32_bf16 v[212:215], v[180:183], v[196:199], v[212:215]
    ds_read_b64_tr_b16 v[102:103], v223 offset:12288
    s_nop 6
    v_max3_f32 v36, v36, v212, v213
    v_max3_f32 v36, v36, v214, v215
    v_mov_b32 v37, v36
    s_nop 1
    v_permlane32_swap_b32 v36, v37
    s_nop 0
    v_max_f32 v36, v36, v37
    v_mov_b32 v37, v36
    s_nop 1
    v_permlane16_swap_b32 v36, v37
    s_nop 0
    v_max_f32 v36, v36, v37
    v_mul_f32 v244, 0xbe0293ee, v36
    v_mul_f32 v245, 0xbe0293ee, v36
    v_pk_fma_f32 v[200:201], v[200:201], v[242:243], v[244:245]
    v_pk_fma_f32 v[202:203], v[202:203], v[242:243], v[244:245]
    v_pk_fma_f32 v[204:205], v[204:205], v[242:243], v[244:245]
    v_pk_fma_f32 v[206:207], v[206:207], v[242:243], v[244:245]
    v_exp_f32 v200, v200
    v_exp_f32 v201, v201
    v_pk_fma_f32 v[208:209], v[208:209], v[242:243], v[244:245]
    v_exp_f32 v202, v202
    v_exp_f32 v203, v203
    v_pk_fma_f32 v[210:211], v[210:211], v[242:243], v[244:245]
    v_exp_f32 v204, v204
    v_exp_f32 v205, v205
    v_pk_fma_f32 v[212:213], v[212:213], v[242:243], v[244:245]
    v_exp_f32 v206, v206
    v_exp_f32 v207, v207
    v_pk_fma_f32 v[214:215], v[214:215], v[242:243], v[244:245]
    s_waitcnt lgkmcnt(0)
    v_cvt_pk_bf16_f32 v216, v200, v201
    v_cvt_pk_bf16_f32 v217, v202, v203
    v_cvt_pk_bf16_f32 v218, v204, v205
    v_cvt_pk_bf16_f32 v219, v206, v207
    v_exp_f32 v208, v208
    v_exp_f32 v209, v209
    v_mfma_f32_16x16x32_bf16 v[152:155], v[248:251], v[216:219], 0
    v_exp_f32 v210, v210
    v_mfma_f32_16x16x32_bf16 v[120:123], v[40:43], v[216:219], 0
    v_exp_f32 v211, v211
    v_mfma_f32_16x16x32_bf16 v[124:127], v[48:51], v[216:219], 0
    v_exp_f32 v212, v212
    v_mfma_f32_16x16x32_bf16 v[128:131], v[56:59], v[216:219], 0
    v_exp_f32 v213, v213
    v_mfma_f32_16x16x32_bf16 v[132:135], v[64:67], v[216:219], 0
    v_exp_f32 v214, v214
    v_mfma_f32_16x16x32_bf16 v[136:139], v[72:75], v[216:219], 0
    v_exp_f32 v215, v215
    v_mfma_f32_16x16x32_bf16 v[140:143], v[80:83], v[216:219], 0
    v_mfma_f32_16x16x32_bf16 v[144:147], v[88:91], v[216:219], 0
    v_mfma_f32_16x16x32_bf16 v[148:151], v[96:99], v[216:219], 0
    v_cvt_pk_bf16_f32 v220, v208, v209
    v_cvt_pk_bf16_f32 v221, v210, v211
    v_cvt_pk_bf16_f32 v222, v212, v213
    v_cvt_pk_bf16_f32 v223, v214, v215
    s_add_u32 s26, s87, 4096
    s_nop 0
    v_mfma_f32_16x16x32_bf16 v[152:155], v[248:251], v[220:223], v[152:155]
    v_mfma_f32_16x16x32_bf16 v[120:123], v[44:47], v[220:223], v[120:123]
    v_mfma_f32_16x16x32_bf16 v[124:127], v[52:55], v[220:223], v[124:127]
    v_mfma_f32_16x16x32_bf16 v[128:131], v[60:63], v[220:223], v[128:131]
    v_mfma_f32_16x16x32_bf16 v[132:135], v[68:71], v[220:223], v[132:135]
    s_nop 3
    v_rcp_f32 v244, v152
    v_mfma_f32_16x16x32_bf16 v[136:139], v[76:79], v[220:223], v[136:139]
    v_mov_b32 v245, v244
    v_mfma_f32_16x16x32_bf16 v[140:143], v[84:87], v[220:223], v[140:143]
    v_pk_mul_f32 v[120:121], v[120:121], v[244:245]
    v_pk_mul_f32 v[122:123], v[122:123], v[244:245]
    v_pk_mul_f32 v[124:125], v[124:125], v[244:245]
    v_pk_mul_f32 v[126:127], v[126:127], v[244:245]
    v_cvt_pk_bf16_f32 v156, v120, v121
    v_cvt_pk_bf16_f32 v157, v122, v123
    v_cvt_pk_bf16_f32 v158, v124, v125
    v_cvt_pk_bf16_f32 v159, v126, v127
    buffer_store_dwordx4 v[156:159], v240, s[44:47], s87 offen offset:0 sc1
    v_mfma_f32_16x16x32_bf16 v[144:147], v[92:95], v[220:223], v[144:147]
    v_mfma_f32_16x16x32_bf16 v[148:151], v[100:103], v[220:223], v[148:151]
    v_pk_mul_f32 v[128:129], v[128:129], v[244:245]
    v_pk_mul_f32 v[130:131], v[130:131], v[244:245]
    v_pk_mul_f32 v[132:133], v[132:133], v[244:245]
    v_pk_mul_f32 v[134:135], v[134:135], v[244:245]
    v_cvt_pk_bf16_f32 v160, v128, v129
    v_cvt_pk_bf16_f32 v161, v130, v131
    v_cvt_pk_bf16_f32 v162, v132, v133
    v_cvt_pk_bf16_f32 v163, v134, v135
    buffer_store_dwordx4 v[160:163], v240, s[44:47], s87 offen offset:2048 sc1
    v_pk_mul_f32 v[136:137], v[136:137], v[244:245]
    v_pk_mul_f32 v[138:139], v[138:139], v[244:245]
    v_pk_mul_f32 v[140:141], v[140:141], v[244:245]
    v_pk_mul_f32 v[142:143], v[142:143], v[244:245]
    v_cvt_pk_bf16_f32 v164, v136, v137
    v_cvt_pk_bf16_f32 v165, v138, v139
    v_cvt_pk_bf16_f32 v166, v140, v141
    v_cvt_pk_bf16_f32 v167, v142, v143
    buffer_store_dwordx4 v[164:167], v240, s[44:47], s26 offen offset:0 sc1
    v_pk_mul_f32 v[144:145], v[144:145], v[244:245]
    v_pk_mul_f32 v[146:147], v[146:147], v[244:245]
    v_pk_mul_f32 v[148:149], v[148:149], v[244:245]
    v_pk_mul_f32 v[150:151], v[150:151], v[244:245]
    v_cvt_pk_bf16_f32 v168, v144, v145
    v_cvt_pk_bf16_f32 v169, v146, v147
    v_cvt_pk_bf16_f32 v170, v148, v149
    v_cvt_pk_bf16_f32 v171, v150, v151
    buffer_store_dwordx4 v[168:171], v240, s[44:47], s26 offen offset:2048 sc1
    s_add_u32 m0, s85, 122880
    s_add_u32 s84, s86, 983040
    buffer_load_dwordx4 v14, s[48:51], s84 offen lds
    s_add_u32 m0, s85, 126976
    s_add_u32 s84, s86, 1015808
    buffer_load_dwordx4 v14, s[48:51], s84 offen lds
    s_add_u32 m0, s85, 24576
    s_add_u32 s84, s86, 196608
    buffer_load_dwordx4 v14, s[48:51], s84 offen lds
    s_add_u32 m0, s85, 28672
    s_add_u32 s84, s86, 229376
    buffer_load_dwordx4 v14, s[48:51], s84 offen lds
    s_add_u32 m0, s85, 90112
    s_add_u32 s84, s86, 720896
    buffer_load_dwordx4 v14, s[48:51], s84 offen lds
    s_add_u32 m0, s85, 94208
    s_add_u32 s84, s86, 753664
    buffer_load_dwordx4 v14, s[48:51], s84 offen lds
    s_add_u32 m0, s85, 98304
    s_add_u32 s84, s86, 786432
    buffer_load_dwordx4 v14, s[48:51], s84 offen lds
    s_add_u32 m0, s85, 102400
    s_add_u32 s84, s86, 819200
    buffer_load_dwordx4 v14, s[48:51], s84 offen lds
    s_add_u32 m0, s85, 32768
    s_add_u32 s84, s86, 262144
    buffer_load_dwordx4 v14, s[48:51], s84 offen lds
    s_add_u32 m0, s85, 36864
    s_add_u32 s84, s86, 294912
    buffer_load_dwordx4 v14, s[48:51], s84 offen lds
    s_add_u32 m0, s85, 106496
    s_add_u32 s84, s86, 851968
    buffer_load_dwordx4 v14, s[48:51], s84 offen lds
    s_add_u32 m0, s85, 110592
    s_add_u32 s84, s86, 884736
    buffer_load_dwordx4 v14, s[48:51], s84 offen lds
    s_lshr_b32 s62, s20, 1
    s_and_b32 s63, s20, 1
    s_lshl_b32 s25, s22, 1
    s_add_u32 s25, s25, s63
    s_lshl_b32 s25, s25, 5
    s_lshl_b32 s26, s68, 3
    s_add_u32 s25, s25, s26
    s_lshl_b32 s26, s62, 2
    s_add_u32 s25, s25, s26
    s_lshl_b32 s25, s25, 13
    s_add_u32 s80, s25, 1048576
    s_and_b32 s25, s68, 1
    s_lshl_b32 s25, s25, 10
    v_add_u32 v10, s25, v240
    s_xor_b32 s25, s25, 1024
    v_add_u32 v11, s25, v240
    s_barrier
    s_waitcnt vmcnt(12)
    v_mov_b32 v36, s67
    v_mul_u32_u24 v37, 16384, v1
    s_mov_b64 exec, 1
    buffer_store_dword v36, v37, s[44:47], s94 offen sc1
    s_mov_b64 exec, -1
    s_add_u32 m0, s85, 114688
    s_add_u32 s84, s86, 917504
    buffer_load_dwordx4 v14, s[48:51], s84 offen lds
    s_add_u32 m0, s85, 118784
    s_add_u32 s84, s86, 950272
    buffer_load_dwordx4 v14, s[48:51], s84 offen lds
    s_add_u32 m0, s85, 0
    s_add_u32 s84, s86, 0
    buffer_load_dwordx4 v14, s[48:51], s84 offen lds
    s_add_u32 m0, s85, 4096
    s_add_u32 s84, s86, 32768
    buffer_load_dwordx4 v14, s[48:51], s84 offen lds
    s_add_u32 m0, s85, 40960
    s_add_u32 s84, s86, 327680
    buffer_load_dwordx4 v14, s[48:51], s84 offen lds
    s_add_u32 m0, s85, 45056
    s_add_u32 s84, s86, 360448
    buffer_load_dwordx4 v14, s[48:51], s84 offen lds
    s_add_u32 m0, s85, 49152
    s_add_u32 s84, s86, 393216
    buffer_load_dwordx4 v14, s[48:51], s84 offen lds
    s_add_u32 m0, s85, 53248
    s_add_u32 s84, s86, 425984
    buffer_load_dwordx4 v14, s[48:51], s84 offen lds
    s_add_u32 m0, s85, 8192
    s_add_u32 s84, s86, 65536
    buffer_load_dwordx4 v14, s[48:51], s84 offen lds
    s_add_u32 m0, s85, 12288
    s_add_u32 s84, s86, 98304
    buffer_load_dwordx4 v14, s[48:51], s84 offen lds
    s_add_u32 m0, s85, 16384
    s_add_u32 s84, s86, 131072
    buffer_load_dwordx4 v14, s[48:51], s84 offen lds
    s_add_u32 m0, s85, 20480
    s_add_u32 s84, s86, 163840
    buffer_load_dwordx4 v14, s[48:51], s84 offen lds
    v_lshrrev_b32 v2, 4, v1
    v_bfe_u32 v3, v1, 2, 2
    v_lshl_add_u32 v3, v2, 2, v3
    v_bfe_u32 v4, v3, 1, 2
    v_lshlrev_b32 v4, 1, v4
    v_bfe_u32 v5, v1, 1, 1
    v_xor_b32 v4, v4, v5
    v_lshlrev_b32 v4, 4, v4
    v_lshl_add_u32 v3, v3, 7, v4
    v_and_b32 v4, 1, v1
    v_lshl_add_u32 v3, v4, 3, v3
    s_lshl_b32 s64, s62, 16
    v_add_u32 v3, s64, v3
    s_xor_b32 s25, s62, 1
    s_lshl_b32 s25, s25, 1
    s_lshr_b32 s26, s68, 1
    s_xor_b32 s25, s25, s26
    s_lshl_b32 s25, s25, 5
    v_xor_b32 v17, s25, v3
    v_xor_b32 v18, 32, v17
    v_xor_b32 v19, 64, v17
    v_xor_b32 v20, 96, v17
    s_mov_b32 s88, 0x07060500
    s_mov_b32 s89, 0x07060501
    s_mov_b32 s90, 0x07060502
    s_mov_b32 s91, 0x07060503
    s_mov_b32 s92, 0x0c0c0400
    s_mov_b32 s93, 0x04000c0c
    s_lshl_b32 s25, s20, 12
    s_add_u32 s25, s25, 147456
    v_add_u32 v2, s25, v240
    s_xor_b32 s26, s20, 2
    s_lshl_b32 s26, s26, 12
    s_add_u32 s26, s26, 147456
    v_add_u32 v3, s26, v240
    v_mov_b32 v4, s67
    v_mov_b32 v12, 0x80
    s_lshl_b32 s25, s22, 3
    s_add_u32 s25, s25, s69
    s_lshl_b32 s64, s25, 16
    s_add_u32 s64, s64, 6291456
    s_lshl_b32 s26, s20, 10
    s_add_u32 s64, s64, s26
    s_lshl_b32 s26, s68, 12
    s_add_u32 s65, s64, s26
    s_lshl_b32 s26, s68, 14
    s_add_u32 s64, s64, s26
    s_xor_b32 s25, s68, 1
    s_lshl_b32 s26, s25, 14
    s_add_u32 s81, s65, s26
    s_lshl_b32 s26, s25, 12
    s_add_u32 s60, s64, s26
    s_xor_b32 s25, s68, 2
    s_lshl_b32 s26, s25, 14
    s_add_u32 s82, s65, s26
    s_lshl_b32 s26, s25, 12
    s_add_u32 s61, s64, s26
    s_xor_b32 s25, s68, 3
    s_lshl_b32 s26, s25, 14
    s_add_u32 s83, s65, s26
    s_lshl_b32 s26, s25, 12
    s_add_u32 s58, s64, s26
    s_and_b32 s25, s20, 1
    s_lshl_b32 s25, s25, 1
    s_and_b32 s26, s68, 1
    s_add_u32 s25, s25, s26
    s_lshl_b32 s25, s25, 4
    s_lshl_b32 s26, s22, 6
    s_add_u32 s25, s25, s26
    s_lshl_b32 s25, s25, 10
    s_lshr_b32 s26, s20, 1
    s_lshl_b32 s26, s26, 1
    s_lshr_b32 s27, s68, 1
    s_add_u32 s26, s26, s27
    s_lshl_b32 s26, s26, 5
    s_add_u32 s25, s25, s26
    s_lshl_b32 s26, s69, 7
    s_add_u32 s57, s25, s26
    v_and_b32 v5, 15, v1
    v_lshrrev_b32 v6, 4, v1
    v_lshlrev_b32 v6, 3, v6
    v_lshl_add_u32 v5, v5, 10, v6
    buffer_load_dword v241, v35, s[44:47], 0 offen sc1
    s_add_u32 m0, s85, 73728
    s_add_u32 s84, s86, 589824
    buffer_load_dwordx4 v14, s[48:51], s84 offen lds
    s_add_u32 m0, s85, 77824
    s_add_u32 s84, s86, 622592
    buffer_load_dwordx4 v14, s[48:51], s84 offen lds
    s_add_u32 m0, s85, 81920
    s_add_u32 s84, s86, 655360
    buffer_load_dwordx4 v14, s[48:51], s84 offen lds
    s_add_u32 m0, s85, 86016
    s_add_u32 s84, s86, 688128
    buffer_load_dwordx4 v14, s[48:51], s84 offen lds
    s_add_u32 m0, s85, 57344
    s_add_u32 s84, s86, 458752
    buffer_load_dwordx4 v14, s[48:51], s84 offen lds
    s_add_u32 m0, s85, 61440
    s_add_u32 s84, s86, 491520
    buffer_load_dwordx4 v14, s[48:51], s84 offen lds
    s_add_u32 m0, s85, 65536
    s_add_u32 s84, s86, 524288
    buffer_load_dwordx4 v14, s[48:51], s84 offen lds
    s_add_u32 m0, s85, 69632
    s_add_u32 s84, s86, 557056
    buffer_load_dwordx4 v14, s[48:51], s84 offen lds
    s_waitcnt vmcnt(8)
    v_cmp_ne_u32 vcc, s67, v241
    s_cbranch_vccz L_f1ok_4
    s_mov_b32 s71, 1
L_poll_5:
    s_and_b32 s27, s71, 0
    s_mul_i32 s27, s27, 16384
    buffer_load_dword v241, v35, s[44:47], s27 offen sc1
    s_add_u32 s71, s71, 1
    s_waitcnt vmcnt(0)
    v_cmp_ne_u32 vcc, s67, v241
    s_cmp_ge_u32 s71, 40000
    s_cbranch_scc1 L_polled_6
    s_cbranch_vccz L_polled_6
    s_branch L_poll_5
L_polled_6:
L_f1ok_4:
    buffer_load_dwordx4 v[112:115], v10, s[44:47], s80 offen offset:0 sc1
    buffer_load_dwordx4 v[116:119], v11, s[44:47], s80 offen offset:0 sc1
    buffer_load_dwordx4 v[120:123], v10, s[44:47], s80 offen offset:2048 sc1
    buffer_load_dwordx4 v[124:127], v11, s[44:47], s80 offen offset:2048 sc1
    s_add_u32 s80, s80, 4096
    buffer_load_dwordx4 v[128:131], v10, s[44:47], s80 offen offset:0 sc1
    buffer_load_dwordx4 v[132:135], v11, s[44:47], s80 offen offset:0 sc1
    buffer_load_dwordx4 v[136:139], v10, s[44:47], s80 offen offset:2048 sc1
    buffer_load_dwordx4 v[140:143], v11, s[44:47], s80 offen offset:2048 sc1
    s_add_u32 s80, s80, 4096
    buffer_load_dwordx4 v[144:147], v10, s[44:47], s80 offen offset:0 sc1
    buffer_load_dwordx4 v[148:151], v11, s[44:47], s80 offen offset:0 sc1
    buffer_load_dwordx4 v[152:155], v10, s[44:47], s80 offen offset:2048 sc1
    buffer_load_dwordx4 v[156:159], v11, s[44:47], s80 offen offset:2048 sc1
    s_waitcnt vmcnt(12)
    s_barrier
    ds_read_b64_tr_b16 v[64:65], v17 offset:0
    ds_read_b64_tr_b16 v[66:67], v17 offset:2048
    ds_read_b64_tr_b16 v[68:69], v18 offset:0
    ds_read_b64_tr_b16 v[70:71], v18 offset:2048
    ds_read_b64_tr_b16 v[72:73], v19 offset:0
    ds_read_b64_tr_b16 v[74:75], v19 offset:2048
    ds_read_b64_tr_b16 v[76:77], v20 offset:0
    ds_read_b64_tr_b16 v[78:79], v20 offset:2048
    ds_read_b64_tr_b16 v[80:81], v17 offset:4096
    ds_read_b64_tr_b16 v[82:83], v17 offset:6144
    ds_read_b64_tr_b16 v[84:85], v18 offset:4096
    ds_read_b64_tr_b16 v[86:87], v18 offset:6144
    ds_read_b64_tr_b16 v[88:89], v19 offset:4096
    ds_read_b64_tr_b16 v[90:91], v19 offset:6144
    s_waitcnt lgkmcnt(12)
    ds_read_b64_tr_b16 v[92:93], v20 offset:4096
    ds_read_b64_tr_b16 v[94:95], v20 offset:6144
    s_waitcnt vmcnt(10) lgkmcnt(7)
    v_mfma_f32_16x16x32_bf16 v[32:35], v[64:67], v[112:115], 0
    ds_read_b64_tr_b16 v[96:97], v17 offset:8192
    v_mfma_f32_16x16x32_bf16 v[36:39], v[64:67], v[116:119], 0
    ds_read_b64_tr_b16 v[98:99], v17 offset:10240
    s_add_u32 s80, s80, 4096
    buffer_load_dwordx4 v[160:163], v10, s[44:47], s80 offen offset:0 sc1
    v_mfma_f32_16x16x32_bf16 v[40:43], v[68:71], v[112:115], 0
    ds_read_b64_tr_b16 v[100:101], v18 offset:8192
    v_mfma_f32_16x16x32_bf16 v[44:47], v[68:71], v[116:119], 0
    ds_read_b64_tr_b16 v[102:103], v18 offset:10240
    v_mfma_f32_16x16x32_bf16 v[48:51], v[72:75], v[112:115], 0
    ds_read_b64_tr_b16 v[104:105], v19 offset:8192
    v_mfma_f32_16x16x32_bf16 v[52:55], v[72:75], v[116:119], 0
    ds_read_b64_tr_b16 v[106:107], v19 offset:10240
    buffer_load_dwordx4 v[164:167], v11, s[44:47], s80 offen offset:0 sc1
    v_mfma_f32_16x16x32_bf16 v[56:59], v[76:79], v[112:115], 0
    ds_read_b64_tr_b16 v[108:109], v20 offset:8192
    v_mfma_f32_16x16x32_bf16 v[60:63], v[76:79], v[116:119], 0
    ds_read_b64_tr_b16 v[110:111], v20 offset:10240
    s_waitcnt vmcnt(10) lgkmcnt(7)
    v_mfma_f32_16x16x32_bf16 v[32:35], v[80:83], v[120:123], v[32:35]
    ds_read_b64_tr_b16 v[64:65], v17 offset:12288
    v_mfma_f32_16x16x32_bf16 v[36:39], v[80:83], v[124:127], v[36:39]
    ds_read_b64_tr_b16 v[66:67], v17 offset:14336
    buffer_load_dwordx4 v[168:171], v10, s[44:47], s80 offen offset:2048 sc1
    v_mfma_f32_16x16x32_bf16 v[40:43], v[84:87], v[120:123], v[40:43]
    ds_read_b64_tr_b16 v[68:69], v18 offset:12288
    v_mfma_f32_16x16x32_bf16 v[44:47], v[84:87], v[124:127], v[44:47]
    ds_read_b64_tr_b16 v[70:71], v18 offset:14336
    v_mfma_f32_16x16x32_bf16 v[48:51], v[88:91], v[120:123], v[48:51]
    ds_read_b64_tr_b16 v[72:73], v19 offset:12288
    v_mfma_f32_16x16x32_bf16 v[52:55], v[88:91], v[124:127], v[52:55]
    ds_read_b64_tr_b16 v[74:75], v19 offset:14336
    buffer_load_dwordx4 v[172:175], v11, s[44:47], s80 offen offset:2048 sc1
    v_mfma_f32_16x16x32_bf16 v[56:59], v[92:95], v[120:123], v[56:59]
    ds_read_b64_tr_b16 v[76:77], v20 offset:12288
    v_mfma_f32_16x16x32_bf16 v[60:63], v[92:95], v[124:127], v[60:63]
    ds_read_b64_tr_b16 v[78:79], v20 offset:14336
    s_waitcnt vmcnt(10) lgkmcnt(7)
    v_mfma_f32_16x16x32_bf16 v[32:35], v[96:99], v[128:131], v[32:35]
    ds_read_b64_tr_b16 v[80:81], v17 offset:16384
    v_mfma_f32_16x16x32_bf16 v[36:39], v[96:99], v[132:135], v[36:39]
    ds_read_b64_tr_b16 v[82:83], v17 offset:18432
    s_add_u32 s80, s80, 4096
    buffer_load_dwordx4 v[176:179], v10, s[44:47], s80 offen offset:0 sc1
    v_mfma_f32_16x16x32_bf16 v[40:43], v[100:103], v[128:131], v[40:43]
    ds_read_b64_tr_b16 v[84:85], v18 offset:16384
    v_mfma_f32_16x16x32_bf16 v[44:47], v[100:103], v[132:135], v[44:47]
    ds_read_b64_tr_b16 v[86:87], v18 offset:18432
    v_mfma_f32_16x16x32_bf16 v[48:51], v[104:107], v[128:131], v[48:51]
    ds_read_b64_tr_b16 v[88:89], v19 offset:16384
    v_mfma_f32_16x16x32_bf16 v[52:55], v[104:107], v[132:135], v[52:55]
    ds_read_b64_tr_b16 v[90:91], v19 offset:18432
    buffer_load_dwordx4 v[180:183], v11, s[44:47], s80 offen offset:0 sc1
    v_mfma_f32_16x16x32_bf16 v[56:59], v[108:111], v[128:131], v[56:59]
    ds_read_b64_tr_b16 v[92:93], v20 offset:16384
    v_mfma_f32_16x16x32_bf16 v[60:63], v[108:111], v[132:135], v[60:63]
    ds_read_b64_tr_b16 v[94:95], v20 offset:18432
    s_waitcnt vmcnt(10) lgkmcnt(7)
    v_mfma_f32_16x16x32_bf16 v[32:35], v[64:67], v[136:139], v[32:35]
    ds_read_b64_tr_b16 v[96:97], v17 offset:20480
    v_mfma_f32_16x16x32_bf16 v[36:39], v[64:67], v[140:143], v[36:39]
    ds_read_b64_tr_b16 v[98:99], v17 offset:22528
    buffer_load_dwordx4 v[184:187], v10, s[44:47], s80 offen offset:2048 sc1
    v_mfma_f32_16x16x32_bf16 v[40:43], v[68:71], v[136:139], v[40:43]
    ds_read_b64_tr_b16 v[100:101], v18 offset:20480
    v_mfma_f32_16x16x32_bf16 v[44:47], v[68:71], v[140:143], v[44:47]
    ds_read_b64_tr_b16 v[102:103], v18 offset:22528
    v_mfma_f32_16x16x32_bf16 v[48:51], v[72:75], v[136:139], v[48:51]
    ds_read_b64_tr_b16 v[104:105], v19 offset:20480
    v_mfma_f32_16x16x32_bf16 v[52:55], v[72:75], v[140:143], v[52:55]
    ds_read_b64_tr_b16 v[106:107], v19 offset:22528
    buffer_load_dwordx4 v[188:191], v11, s[44:47], s80 offen offset:2048 sc1
    v_mfma_f32_16x16x32_bf16 v[56:59], v[76:79], v[136:139], v[56:59]
    ds_read_b64_tr_b16 v[108:109], v20 offset:20480
    v_mfma_f32_16x16x32_bf16 v[60:63], v[76:79], v[140:143], v[60:63]
    ds_read_b64_tr_b16 v[110:111], v20 offset:22528
    s_waitcnt vmcnt(10) lgkmcnt(7)
    v_mfma_f32_16x16x32_bf16 v[32:35], v[80:83], v[144:147], v[32:35]
    ds_read_b64_tr_b16 v[64:65], v17 offset:24576
    v_mfma_f32_16x16x32_bf16 v[36:39], v[80:83], v[148:151], v[36:39]
    ds_read_b64_tr_b16 v[66:67], v17 offset:26624
    s_add_u32 s80, s80, 4096
    buffer_load_dwordx4 v[192:195], v10, s[44:47], s80 offen offset:0 sc1
    v_mfma_f32_16x16x32_bf16 v[40:43], v[84:87], v[144:147], v[40:43]
    ds_read_b64_tr_b16 v[68:69], v18 offset:24576
    v_mfma_f32_16x16x32_bf16 v[44:47], v[84:87], v[148:151], v[44:47]
    ds_read_b64_tr_b16 v[70:71], v18 offset:26624
    v_mfma_f32_16x16x32_bf16 v[48:51], v[88:91], v[144:147], v[48:51]
    ds_read_b64_tr_b16 v[72:73], v19 offset:24576
    v_mfma_f32_16x16x32_bf16 v[52:55], v[88:91], v[148:151], v[52:55]
    ds_read_b64_tr_b16 v[74:75], v19 offset:26624
    buffer_load_dwordx4 v[196:199], v11, s[44:47], s80 offen offset:0 sc1
    v_mfma_f32_16x16x32_bf16 v[56:59], v[92:95], v[144:147], v[56:59]
    ds_read_b64_tr_b16 v[76:77], v20 offset:24576
    v_mfma_f32_16x16x32_bf16 v[60:63], v[92:95], v[148:151], v[60:63]
    ds_read_b64_tr_b16 v[78:79], v20 offset:26624
    s_waitcnt vmcnt(10) lgkmcnt(7)
    v_mfma_f32_16x16x32_bf16 v[32:35], v[96:99], v[152:155], v[32:35]
    ds_read_b64_tr_b16 v[80:81], v17 offset:28672
    v_mfma_f32_16x16x32_bf16 v[36:39], v[96:99], v[156:159], v[36:39]
    ds_read_b64_tr_b16 v[82:83], v17 offset:30720
    buffer_load_dwordx4 v[200:203], v10, s[44:47], s80 offen offset:2048 sc1
    v_mfma_f32_16x16x32_bf16 v[40:43], v[100:103], v[152:155], v[40:43]
    ds_read_b64_tr_b16 v[84:85], v18 offset:28672
    v_mfma_f32_16x16x32_bf16 v[44:47], v[100:103], v[156:159], v[44:47]
    ds_read_b64_tr_b16 v[86:87], v18 offset:30720
    v_mfma_f32_16x16x32_bf16 v[48:51], v[104:107], v[152:155], v[48:51]
    ds_read_b64_tr_b16 v[88:89], v19 offset:28672
    v_mfma_f32_16x16x32_bf16 v[52:55], v[104:107], v[156:159], v[52:55]
    ds_read_b64_tr_b16 v[90:91], v19 offset:30720
    buffer_load_dwordx4 v[204:207], v11, s[44:47], s80 offen offset:2048 sc1
    v_mfma_f32_16x16x32_bf16 v[56:59], v[108:111], v[152:155], v[56:59]
    ds_read_b64_tr_b16 v[92:93], v20 offset:28672
    v_mfma_f32_16x16x32_bf16 v[60:63], v[108:111], v[156:159], v[60:63]
    ds_read_b64_tr_b16 v[94:95], v20 offset:30720
    s_waitcnt vmcnt(10) lgkmcnt(7)
    v_mfma_f32_16x16x32_bf16 v[32:35], v[64:67], v[160:163], v[32:35]
    ds_read_b64_tr_b16 v[96:97], v17 offset:32768
    v_mfma_f32_16x16x32_bf16 v[36:39], v[64:67], v[164:167], v[36:39]
    ds_read_b64_tr_b16 v[98:99], v17 offset:34816
    s_add_u32 s80, s80, 4096
    buffer_load_dwordx4 v[208:211], v10, s[44:47], s80 offen offset:0 sc1
    v_mfma_f32_16x16x32_bf16 v[40:43], v[68:71], v[160:163], v[40:43]
    ds_read_b64_tr_b16 v[100:101], v18 offset:32768
    v_mfma_f32_16x16x32_bf16 v[44:47], v[68:71], v[164:167], v[44:47]
    ds_read_b64_tr_b16 v[102:103], v18 offset:34816
    v_mfma_f32_16x16x32_bf16 v[48:51], v[72:75], v[160:163], v[48:51]
    ds_read_b64_tr_b16 v[104:105], v19 offset:32768
    v_mfma_f32_16x16x32_bf16 v[52:55], v[72:75], v[164:167], v[52:55]
    ds_read_b64_tr_b16 v[106:107], v19 offset:34816
    buffer_load_dwordx4 v[212:215], v11, s[44:47], s80 offen offset:0 sc1
    v_mfma_f32_16x16x32_bf16 v[56:59], v[76:79], v[160:163], v[56:59]
    ds_read_b64_tr_b16 v[108:109], v20 offset:32768
    v_mfma_f32_16x16x32_bf16 v[60:63], v[76:79], v[164:167], v[60:63]
    ds_read_b64_tr_b16 v[110:111], v20 offset:34816
    s_waitcnt vmcnt(10) lgkmcnt(7)
    v_mfma_f32_16x16x32_bf16 v[32:35], v[80:83], v[168:171], v[32:35]
    ds_read_b64_tr_b16 v[64:65], v17 offset:36864
    v_mfma_f32_16x16x32_bf16 v[36:39], v[80:83], v[172:175], v[36:39]
    ds_read_b64_tr_b16 v[66:67], v17 offset:38912
    buffer_load_dwordx4 v[216:219], v10, s[44:47], s80 offen offset:2048 sc1
    v_mfma_f32_16x16x32_bf16 v[40:43], v[84:87], v[168:171], v[40:43]
    ds_read_b64_tr_b16 v[68:69], v18 offset:36864
    v_mfma_f32_16x16x32_bf16 v[44:47], v[84:87], v[172:175], v[44:47]
    ds_read_b64_tr_b16 v[70:71], v18 offset:38912
    v_mfma_f32_16x16x32_bf16 v[48:51], v[88:91], v[168:171], v[48:51]
    ds_read_b64_tr_b16 v[72:73], v19 offset:36864
    v_mfma_f32_16x16x32_bf16 v[52:55], v[88:91], v[172:175], v[52:55]
    ds_read_b64_tr_b16 v[74:75], v19 offset:38912
    buffer_load_dwordx4 v[220:223], v11, s[44:47], s80 offen offset:2048 sc1
    v_mfma_f32_16x16x32_bf16 v[56:59], v[92:95], v[168:171], v[56:59]
    ds_read_b64_tr_b16 v[76:77], v20 offset:36864
    v_mfma_f32_16x16x32_bf16 v[60:63], v[92:95], v[172:175], v[60:63]
    ds_read_b64_tr_b16 v[78:79], v20 offset:38912
    s_waitcnt vmcnt(10) lgkmcnt(7)
    v_mfma_f32_16x16x32_bf16 v[32:35], v[96:99], v[176:179], v[32:35]
    ds_read_b64_tr_b16 v[80:81], v17 offset:40960
    v_mfma_f32_16x16x32_bf16 v[36:39], v[96:99], v[180:183], v[36:39]
    ds_read_b64_tr_b16 v[82:83], v17 offset:43008
    s_add_u32 s80, s80, 4096
    buffer_load_dwordx4 v[224:227], v10, s[44:47], s80 offen offset:0 sc1
    v_mfma_f32_16x16x32_bf16 v[40:43], v[100:103], v[176:179], v[40:43]
    ds_read_b64_tr_b16 v[84:85], v18 offset:40960
    v_mfma_f32_16x16x32_bf16 v[44:47], v[100:103], v[180:183], v[44:47]
    ds_read_b64_tr_b16 v[86:87], v18 offset:43008
    v_mfma_f32_16x16x32_bf16 v[48:51], v[104:107], v[176:179], v[48:51]
    ds_read_b64_tr_b16 v[88:89], v19 offset:40960
    v_mfma_f32_16x16x32_bf16 v[52:55], v[104:107], v[180:183], v[52:55]
    ds_read_b64_tr_b16 v[90:91], v19 offset:43008
    buffer_load_dwordx4 v[228:231], v11, s[44:47], s80 offen offset:0 sc1
    v_mfma_f32_16x16x32_bf16 v[56:59], v[108:111], v[176:179], v[56:59]
    ds_read_b64_tr_b16 v[92:93], v20 offset:40960
    v_mfma_f32_16x16x32_bf16 v[60:63], v[108:111], v[180:183], v[60:63]
    ds_read_b64_tr_b16 v[94:95], v20 offset:43008
    s_waitcnt vmcnt(10) lgkmcnt(7)
    v_mfma_f32_16x16x32_bf16 v[32:35], v[64:67], v[184:187], v[32:35]
    ds_read_b64_tr_b16 v[96:97], v17 offset:45056
    v_mfma_f32_16x16x32_bf16 v[36:39], v[64:67], v[188:191], v[36:39]
    ds_read_b64_tr_b16 v[98:99], v17 offset:47104
    buffer_load_dwordx4 v[232:235], v10, s[44:47], s80 offen offset:2048 sc1
    v_mfma_f32_16x16x32_bf16 v[40:43], v[68:71], v[184:187], v[40:43]
    ds_read_b64_tr_b16 v[100:101], v18 offset:45056
    v_mfma_f32_16x16x32_bf16 v[44:47], v[68:71], v[188:191], v[44:47]
    ds_read_b64_tr_b16 v[102:103], v18 offset:47104
    v_mfma_f32_16x16x32_bf16 v[48:51], v[72:75], v[184:187], v[48:51]
    ds_read_b64_tr_b16 v[104:105], v19 offset:45056
    v_mfma_f32_16x16x32_bf16 v[52:55], v[72:75], v[188:191], v[52:55]
    ds_read_b64_tr_b16 v[106:107], v19 offset:47104
    buffer_load_dwordx4 v[236:239], v11, s[44:47], s80 offen offset:2048 sc1
    v_mfma_f32_16x16x32_bf16 v[56:59], v[76:79], v[184:187], v[56:59]
    ds_read_b64_tr_b16 v[108:109], v20 offset:45056
    v_mfma_f32_16x16x32_bf16 v[60:63], v[76:79], v[188:191], v[60:63]
    ds_read_b64_tr_b16 v[110:111], v20 offset:47104
    s_waitcnt vmcnt(10) lgkmcnt(7)
    v_mfma_f32_16x16x32_bf16 v[32:35], v[80:83], v[192:195], v[32:35]
    ds_read_b64_tr_b16 v[64:65], v17 offset:49152
    v_mfma_f32_16x16x32_bf16 v[36:39], v[80:83], v[196:199], v[36:39]
    ds_read_b64_tr_b16 v[66:67], v17 offset:51200
    v_mfma_f32_16x16x32_bf16 v[40:43], v[84:87], v[192:195], v[40:43]
    ds_read_b64_tr_b16 v[68:69], v18 offset:49152
    v_mfma_f32_16x16x32_bf16 v[44:47], v[84:87], v[196:199], v[44:47]
    ds_read_b64_tr_b16 v[70:71], v18 offset:51200
    v_mfma_f32_16x16x32_bf16 v[48:51], v[88:91], v[192:195], v[48:51]
    ds_read_b64_tr_b16 v[72:73], v19 offset:49152
    v_mfma_f32_16x16x32_bf16 v[52:55], v[88:91], v[196:199], v[52:55]
    ds_read_b64_tr_b16 v[74:75], v19 offset:51200
    v_mfma_f32_16x16x32_bf16 v[56:59], v[92:95], v[192:195], v[56:59]
    ds_read_b64_tr_b16 v[76:77], v20 offset:49152
    v_mfma_f32_16x16x32_bf16 v[60:63], v[92:95], v[196:199], v[60:63]
    ds_read_b64_tr_b16 v[78:79], v20 offset:51200
    s_waitcnt vmcnt(8) lgkmcnt(7)
    v_mfma_f32_16x16x32_bf16 v[32:35], v[96:99], v[200:203], v[32:35]
    ds_read_b64_tr_b16 v[80:81], v17 offset:53248
    v_mfma_f32_16x16x32_bf16 v[36:39], v[96:99], v[204:207], v[36:39]
    ds_read_b64_tr_b16 v[82:83], v17 offset:55296
    v_mfma_f32_16x16x32_bf16 v[40:43], v[100:103], v[200:203], v[40:43]
    ds_read_b64_tr_b16 v[84:85], v18 offset:53248
    v_mfma_f32_16x16x32_bf16 v[44:47], v[100:103], v[204:207], v[44:47]
    ds_read_b64_tr_b16 v[86:87], v18 offset:55296
    v_mfma_f32_16x16x32_bf16 v[48:51], v[104:107], v[200:203], v[48:51]
    ds_read_b64_tr_b16 v[88:89], v19 offset:53248
    v_mfma_f32_16x16x32_bf16 v[52:55], v[104:107], v[204:207], v[52:55]
    ds_read_b64_tr_b16 v[90:91], v19 offset:55296
    v_mfma_f32_16x16x32_bf16 v[56:59], v[108:111], v[200:203], v[56:59]
    ds_read_b64_tr_b16 v[92:93], v20 offset:53248
    v_mfma_f32_16x16x32_bf16 v[60:63], v[108:111], v[204:207], v[60:63]
    ds_read_b64_tr_b16 v[94:95], v20 offset:55296
    s_waitcnt vmcnt(6) lgkmcnt(7)
    v_mfma_f32_16x16x32_bf16 v[32:35], v[64:67], v[208:211], v[32:35]
    ds_read_b64_tr_b16 v[96:97], v17 offset:57344
    v_mfma_f32_16x16x32_bf16 v[36:39], v[64:67], v[212:215], v[36:39]
    ds_read_b64_tr_b16 v[98:99], v17 offset:59392
    v_mfma_f32_16x16x32_bf16 v[40:43], v[68:71], v[208:211], v[40:43]
    ds_read_b64_tr_b16 v[100:101], v18 offset:57344
    v_mfma_f32_16x16x32_bf16 v[44:47], v[68:71], v[212:215], v[44:47]
    ds_read_b64_tr_b16 v[102:103], v18 offset:59392
    v_mfma_f32_16x16x32_bf16 v[48:51], v[72:75], v[208:211], v[48:51]
    ds_read_b64_tr_b16 v[104:105], v19 offset:57344
    v_mfma_f32_16x16x32_bf16 v[52:55], v[72:75], v[212:215], v[52:55]
    ds_read_b64_tr_b16 v[106:107], v19 offset:59392
    v_mfma_f32_16x16x32_bf16 v[56:59], v[76:79], v[208:211], v[56:59]
    ds_read_b64_tr_b16 v[108:109], v20 offset:57344
    v_mfma_f32_16x16x32_bf16 v[60:63], v[76:79], v[212:215], v[60:63]
    ds_read_b64_tr_b16 v[110:111], v20 offset:59392
    s_waitcnt vmcnt(4) lgkmcnt(7)
    v_mfma_f32_16x16x32_bf16 v[32:35], v[80:83], v[216:219], v[32:35]
    ds_read_b64_tr_b16 v[64:65], v17 offset:61440
    v_mfma_f32_16x16x32_bf16 v[36:39], v[80:83], v[220:223], v[36:39]
    ds_read_b64_tr_b16 v[66:67], v17 offset:63488
    v_mfma_f32_16x16x32_bf16 v[40:43], v[84:87], v[216:219], v[40:43]
    ds_read_b64_tr_b16 v[68:69], v18 offset:61440
    v_mfma_f32_16x16x32_bf16 v[44:47], v[84:87], v[220:223], v[44:47]
    ds_read_b64_tr_b16 v[70:71], v18 offset:63488
    v_mfma_f32_16x16x32_bf16 v[48:51], v[88:91], v[216:219], v[48:51]
    ds_read_b64_tr_b16 v[72:73], v19 offset:61440
    v_mfma_f32_16x16x32_bf16 v[52:55], v[88:91], v[220:223], v[52:55]
    ds_read_b64_tr_b16 v[74:75], v19 offset:63488
    v_mfma_f32_16x16x32_bf16 v[56:59], v[92:95], v[216:219], v[56:59]
    ds_read_b64_tr_b16 v[76:77], v20 offset:61440
    v_mfma_f32_16x16x32_bf16 v[60:63], v[92:95], v[220:223], v[60:63]
    ds_read_b64_tr_b16 v[78:79], v20 offset:63488
    s_waitcnt vmcnt(0) lgkmcnt(0)
    v_mfma_f32_16x16x32_bf16 v[32:35], v[96:99], v[224:227], v[32:35]
    v_mfma_f32_16x16x32_bf16 v[36:39], v[96:99], v[228:231], v[36:39]
    v_mfma_f32_16x16x32_bf16 v[40:43], v[100:103], v[224:227], v[40:43]
    v_mfma_f32_16x16x32_bf16 v[44:47], v[100:103], v[228:231], v[44:47]
    v_mfma_f32_16x16x32_bf16 v[32:35], v[64:67], v[232:235], v[32:35]
    v_mfma_f32_16x16x32_bf16 v[36:39], v[64:67], v[236:239], v[36:39]
    v_mfma_f32_16x16x32_bf16 v[40:43], v[68:71], v[232:235], v[40:43]
    v_mfma_f32_16x16x32_bf16 v[44:47], v[68:71], v[236:239], v[44:47]
    v_mfma_f32_16x16x32_bf16 v[48:51], v[104:107], v[224:227], v[48:51]
    v_mfma_f32_16x16x32_bf16 v[52:55], v[104:107], v[228:231], v[52:55]
    v_mfma_f32_16x16x32_bf16 v[56:59], v[108:111], v[224:227], v[56:59]
    v_mfma_f32_16x16x32_bf16 v[60:63], v[108:111], v[228:231], v[60:63]
    v_mfma_f32_16x16x32_bf16 v[48:51], v[72:75], v[232:235], v[48:51]
    ds_write_b128 v2, v[32:35] offset:0
    v_mfma_f32_16x16x32_bf16 v[52:55], v[72:75], v[236:239], v[52:55]
    ds_write_b128 v2, v[36:39] offset:1024
    v_mfma_f32_16x16x32_bf16 v[56:59], v[76:79], v[232:235], v[56:59]
    ds_write_b128 v2, v[40:43] offset:2048
    v_mfma_f32_16x16x32_bf16 v[60:63], v[76:79], v[236:239], v[60:63]
    ds_write_b128 v2, v[44:47] offset:3072
    s_waitcnt lgkmcnt(0)
    s_barrier
    ds_read_b128 v[64:67], v3 offset:0
    ds_read_b128 v[68:71], v3 offset:1024
    ds_read_b128 v[72:75], v3 offset:2048
    ds_read_b128 v[76:79], v3 offset:3072
    s_waitcnt lgkmcnt(2)
    v_pk_add_f32 v[52:53], v[52:53], v[68:69]
    v_pk_add_f32 v[54:55], v[54:55], v[70:71]
    v_perm_b32 v52, v52, v4, s88
    v_perm_b32 v53, v53, v4, s89
    v_perm_b32 v54, v54, v4, s90
    v_perm_b32 v55, v55, v4, s91
    buffer_store_dwordx4 v[52:55], v240, s[44:47], s81 offen sc1
    s_waitcnt lgkmcnt(1)
    v_pk_add_f32 v[56:57], v[56:57], v[72:73]
    v_pk_add_f32 v[58:59], v[58:59], v[74:75]
    v_perm_b32 v56, v56, v4, s88
    v_perm_b32 v57, v57, v4, s89
    v_perm_b32 v58, v58, v4, s90
    v_perm_b32 v59, v59, v4, s91
    buffer_store_dwordx4 v[56:59], v240, s[44:47], s82 offen sc1
    s_waitcnt lgkmcnt(0)
    v_pk_add_f32 v[60:61], v[60:61], v[76:77]
    v_pk_add_f32 v[62:63], v[62:63], v[78:79]
    v_perm_b32 v60, v60, v4, s88
    v_perm_b32 v61, v61, v4, s89
    v_perm_b32 v62, v62, v4, s90
    v_perm_b32 v63, v63, v4, s91
    buffer_store_dwordx4 v[60:63], v240, s[44:47], s83 offen sc1
    v_pk_add_f32 v[48:49], v[48:49], v[64:65]
    v_pk_add_f32 v[50:51], v[50:51], v[66:67]
    s_waitcnt vmcnt(0)
    s_mov_b32 s71, 0
L_gath_8:
    buffer_load_dwordx4 v[112:115], v240, s[44:47], s60 offen sc1
    buffer_load_dwordx4 v[116:119], v240, s[44:47], s61 offen sc1
    buffer_load_dwordx4 v[120:123], v240, s[44:47], s58 offen sc1
    s_add_u32 s71, s71, 1
    s_waitcnt vmcnt(2)
    v_perm_b32 v6, v113, v112, s92
    v_perm_b32 v7, v115, v114, s93
    v_or_b32 v6, v6, v7
    v_xor_b32 v8, v6, v4
    s_waitcnt vmcnt(1)
    v_perm_b32 v6, v117, v116, s92
    v_perm_b32 v7, v119, v118, s93
    v_or_b32 v6, v6, v7
    v_xor_b32 v6, v6, v4
    v_or_b32 v8, v8, v6
    s_waitcnt vmcnt(0)
    v_perm_b32 v6, v121, v120, s92
    v_perm_b32 v7, v123, v122, s93
    v_or_b32 v6, v6, v7
    v_xor_b32 v6, v6, v4
    v_or_b32 v8, v8, v6
    v_cmp_ne_u32 vcc, 0, v8
    s_cmp_ge_u32 s71, 40000
    s_cbranch_scc1 L_gathered_9
    s_cbranch_vccnz L_gath_8
L_gathered_9:
    v_perm_b32 v112, v112, v12, s88
    v_perm_b32 v113, v113, v12, s88
    v_perm_b32 v114, v114, v12, s88
    v_perm_b32 v115, v115, v12, s88
    v_perm_b32 v116, v116, v12, s88
    v_perm_b32 v117, v117, v12, s88
    v_perm_b32 v118, v118, v12, s88
    v_perm_b32 v119, v119, v12, s88
    v_perm_b32 v120, v120, v12, s88
    v_perm_b32 v121, v121, v12, s88
    v_perm_b32 v122, v122, v12, s88
    v_perm_b32 v123, v123, v12, s88
    v_pk_add_f32 v[48:49], v[48:49], v[112:113]
    v_pk_add_f32 v[50:51], v[50:51], v[114:115]
    v_pk_add_f32 v[116:117], v[116:117], v[120:121]
    v_pk_add_f32 v[118:119], v[118:119], v[122:123]
    v_pk_add_f32 v[48:49], v[48:49], v[116:117]
    v_pk_add_f32 v[50:51], v[50:51], v[118:119]
    v_cvt_pk_bf16_f32 v6, v48, v49
    v_cvt_pk_bf16_f32 v7, v50, v51
    buffer_store_dwordx2 v[6:7], v5, s[52:55], s57 offen sc1
    s_or_b32 s25, s23, s66
    s_or_b32 s25, s25, s20
    s_cmp_lg_u32 s25, 0
    s_cbranch_scc1 L_nobump_10
    s_lshl_b32 s25, s22, 7
    s_add_u32 s25, s25, 65536
    v_mov_b32 v3, 0
    s_mov_b64 exec, 1
    buffer_store_dword v4, v3, s[44:47], s25 offen sc1
    s_mov_b64 exec, -1
L_nobump_10:
    s_endpgm
L_done:
    s_endpgm
.section .rodata,"a"
.p2align 6
.amdhsa_kernel standalone__gqa_block_cached__near_ridge_kernel
  .amdhsa_next_free_vgpr 256
  .amdhsa_next_free_sgpr 102
  .amdhsa_accum_offset 256
  .amdhsa_group_segment_fixed_size 0
  .amdhsa_kernarg_size 64
  .amdhsa_user_sgpr_count 2
  .amdhsa_user_sgpr_kernarg_segment_ptr 1
  .amdhsa_system_sgpr_workgroup_id_x 1
.end_amdhsa_kernel
```
